```python
import torch

def _softmax(x, axis=-1):
    return torch.softmax(x, dim=axis)
def _gelu(x):
    return torch.nn.functional.gelu(x, approximate="tanh")
def _silu(x):
    return torch.nn.functional.silu(x)
def _sigmoid(x):
    return torch.sigmoid(x)
def _layernorm(x, axis=-1, eps=1e-5):
    m = x.mean(dim=axis, keepdim=True)
    v = x.var(dim=axis, keepdim=True, unbiased=False)
    return (x - m) / torch.sqrt(v + eps)
def _scatter_add(tgt, idx, src, axis=0):
    return tgt.clone().index_add_(axis, idx, src)
def _segment_sum(src, seg, n):
    out = torch.zeros((n,) + src.shape[1:], dtype=src.dtype)
    return out.index_add_(0, seg, src)
def _pad(x, pw):
    flat = tuple(v for pair in reversed(pw) for v in pair)
    return torch.nn.functional.pad(x, flat)

kernel_name = 'gated_mix__ssm_conv_h3__dense_activation_silu__prompt'

def setup_inputs():

    _w = (lambda a: (lambda t: t.to(torch.bfloat16) if t.is_floating_point() else t)(torch.as_tensor(a)))
    def _A_setup():
        B, S, D = 1, 2048, 640
        ks = 4
        return {
            "q": _w((lambda *s: torch.randn(*s, dtype=torch.bfloat16) * 0.05)(B, S, D)),
            "k": _w((lambda *s: torch.randn(*s, dtype=torch.bfloat16) * 0.2)(B, S, D)),
            "v": _w((lambda *s: torch.randn(*s, dtype=torch.bfloat16) * 0.2)(B, S, D)),
            "shift_k": _w((lambda *s: torch.randn(*s, dtype=torch.bfloat16) * 0.2)(D, ks) * 0.5),
            "ssm_k": _w((lambda *s: torch.randn(*s, dtype=torch.bfloat16) * 0.4)(D, S) * (1.0 / S ** 0.5)),
            "ssm_D": _w((lambda *s: torch.randn(*s, dtype=torch.bfloat16) * 0.2)(D)),
        }
    _A_in = _A_setup()

    def _B_setup():
        B, S, D, F = 1, 2048, 640, 1536
        return {
            "x": _w((lambda *s: torch.randn(*s, dtype=torch.bfloat16) * 0.05)(B, S, D)),
            "w1": _w((lambda *s: torch.randn(*s, dtype=torch.bfloat16) * 3.2)(D, F) * (D ** -0.5)),
            "w2": _w((lambda *s: torch.randn(*s, dtype=torch.bfloat16) * 0.05)(F, D) * (F ** -0.5)),
        }
    _B_in = _B_setup()

    return {
        "A_q": _A_in["q"],
        "A_k": _A_in["k"],
        "A_v": _A_in["v"],
        "A_shift_k": _A_in["shift_k"],
        "A_ssm_k": _A_in["ssm_k"],
        "A_ssm_D": _A_in["ssm_D"],
        "B_x": _B_in["x"],
        "B_w1": _B_in["w1"],
        "B_w2": _B_in["w2"],
        "gate_w": _w((lambda *s: torch.randn(*s, dtype=torch.bfloat16) * 0.05)(640) * 16.0),
    }

def reference(A_q, A_k, A_v, A_shift_k, A_ssm_k, A_ssm_D, B_x, B_w1, B_w2, gate_w):
    def _A_ref(q, k, v, shift_k, ssm_k, ssm_D):
        B, S, D = q.shape
        ks = shift_k.shape[-1]
        k_pad = _pad(k, ((0, 0), (ks - 1, 0), (0, 0)))
        k_shift = torch.zeros_like(k)
        for t in range(ks):
            k_shift = k_shift + k_pad[:, t:t + S, :] * shift_k[:, ks - 1 - t][None, None, :]
        kv = k_shift * v
        L = 2 * S
        kv_pad = _pad(kv, ((0, 0), (0, S), (0, 0)))
        kf_pad = _pad(ssm_k, ((0, 0), (0, S)))
        kv_f = (lambda x, axes=(-2,-1): torch.fft.rfft2(x.float(), dim=axes))(kv_pad[:, None, :, :], axes=(1, 2))
        kf_f = (lambda x, axes=(-2,-1): torch.fft.rfft2(x.float(), dim=axes))(kf_pad[:, None, :], axes=(1, 2))
        kf_f = (lambda x, *d: x.permute(*d))(kf_f, 1, 2, 0)
        y_f = kv_f * kf_f[None, :, :, :]
        y = (lambda x, s, axes=(-2,-1): torch.fft.irfft2(x, s=s, dim=axes).to(torch.bfloat16))(y_f, (1, L), axes=(1, 2))[:, 0, :S, :]
        y = y + kv * ssm_D[None, None, :]
        return q * y

    def _B_ref(x, w1, w2):
        h = torch.einsum("bsd,df->bsf", x, w1)
        h = _silu(h)
        out = torch.einsum("bsf,fd->bsd", h, w2)
        return out

    x = A_q
    g = _sigmoid((x * gate_w).sum(-1, keepdims=True))
    a = _A_ref(x, A_k, A_v, A_shift_k, A_ssm_k, A_ssm_D)
    b = _B_ref(x, B_w1, B_w2)
    return g * a + (1 - g) * b
```

```asm
; @launch grid=(256,1,1) block=(256,1,1) lds=163840
.amdgcn_target "amdgcn-amd-amdhsa--gfx950"
.text
.globl gated_mix__ssm_conv_h3__dense_activation_silu__prompt_kernel
.p2align 12
.type gated_mix__ssm_conv_h3__dense_activation_silu__prompt_kernel,@function
gated_mix__ssm_conv_h3__dense_activation_silu__prompt_kernel:
  s_cmp_ge_u32 s2, 256
  s_cbranch_scc1 Lend
  s_load_dwordx2 s[36:37], s[0:1], 64
  s_load_dwordx2 s[12:13], s[0:1], 8
  s_load_dwordx2 s[16:17], s[0:1], 16
  s_load_dwordx2 s[8:9], s[0:1], 0
  s_load_dwordx2 s[32:33], s[0:1], 56
  s_load_dwordx2 s[48:49], s[0:1], 96
  s_load_dwordx2 s[20:21], s[0:1], 24
  s_load_dwordx2 s[40:41], s[0:1], 72
  s_load_dwordx2 s[24:25], s[0:1], 32
  s_load_dwordx2 s[28:29], s[0:1], 40
  s_load_dwordx2 s[44:45], s[0:1], 80
  v_lshrrev_b32 v20, 6, v0
  v_and_b32 v1, 63, v0
  v_readfirstlane_b32 s3, v20
  s_lshr_b32 s52, s2, 3
  s_and_b32 s5, s52, 3
  s_and_b32 s53, s2, 1
  s_lshl_b32 s53, s53, 2
  s_add_u32 s5, s5, s53
  s_bfe_u32 s4, s2, 0x20001
  s_and_b32 s52, s52, 28
  s_add_u32 s4, s4, s52
  s_mov_b32 s10, 2621440
  s_mov_b32 s11, 0x20000
  s_mov_b32 s14, 2621440
  s_mov_b32 s15, 0x20000
  s_mov_b32 s18, 2621440
  s_mov_b32 s19, 0x20000
  s_mov_b32 s22, 5120
  s_mov_b32 s23, 0x20000
  s_mov_b32 s26, 2621440
  s_mov_b32 s27, 0x20000
  s_mov_b32 s30, 1280
  s_mov_b32 s31, 0x20000
  s_mov_b32 s34, 1966080
  s_mov_b32 s35, 0x20000
  s_mov_b32 s38, 1966080
  s_mov_b32 s39, 0x20000
  s_mov_b32 s42, 1280
  s_mov_b32 s43, 0x20000
  s_mov_b32 s46, 2621440
  s_mov_b32 s47, 0x20000
  s_mov_b32 s50, 16777216
  s_mov_b32 s51, 0x20000
  s_mul_i32 s56, s4, 81920
  s_mul_i32 s52, s5, 160
  s_add_u32 s56, s56, s52
  s_lshl_b32 s57, s3, 10
  s_lshl_b32 s58, s3, 11
  s_movk_i32 s53, 6554
  s_movk_i32 s54, 1120
  s_sub_u32 s55, s56, 5120
  v_mov_b32 v26, v0
  v_mul_u32_u24 v27, s53, v26
  v_lshrrev_b32 v27, 16, v27
  v_lshlrev_b32 v26, 4, v26
  v_mad_u32_u24 v20, v27, s54, v26
  v_add_u32 v23, s55, v20
  v_add_u32 v26, 256, v0
  v_mul_u32_u24 v27, s53, v26
  v_lshrrev_b32 v27, 16, v27
  v_lshlrev_b32 v26, 4, v26
  v_mad_u32_u24 v21, v27, s54, v26
  v_add_u32 v24, s55, v21
  v_add_u32 v26, 512, v0
  v_mul_u32_u24 v27, s53, v26
  v_lshrrev_b32 v27, 16, v27
  v_lshlrev_b32 v26, 4, v26
  v_mad_u32_u24 v22, v27, s54, v26
  v_add_u32 v25, s55, v22
  v_lshlrev_b32 v2, 4, v1
  s_mul_i32 s52, s4, 3
  s_add_u32 s52, s52, s5
  s_mul_i32 s53, s52, 6554
  s_lshr_b32 s53, s53, 16
  s_mul_i32 s53, s53, 10
  s_sub_u32 s6, s52, s53
  v_lshrrev_b32 v26, 3, v1
  v_lshrrev_b32 v27, 4, v1
  v_and_b32 v38, 7, v1
  v_xor_b32 v39, v38, v27
  s_movk_i32 s52, 1280
  s_mul_i32 s53, s3, 20480
  v_lshlrev_b32 v39, 4, v39
  v_mad_u32_u24 v114, v26, s52, v39
  v_add_u32 v114, s53, v114
  v_xor_b32 v115, 64, v114
  v_add_u32 v115, 9216, v115
  s_mul_i32 s7, s4, 81920
  s_lshl_b32 s81, s6, 7
  s_add_u32 s81, s81, s7
  s_add_u32 s7, s7, 1280
  v_and_b32 v27, 1, v27
  v_lshlrev_b32 v27, 2, v27
  v_xor_b32 v39, v38, v27
  v_lshlrev_b32 v39, 4, v39
  s_movk_i32 s52, 3072
  s_mul_i32 s53, s3, 49152
  v_mad_u32_u24 v6, v26, s52, v39
  v_add_u32 v6, s53, v6
  v_add_u32 v14, 23552, v6
  s_mul_i32 s52, s5, 384
  s_mul_i32 s64, s6, 196608
  s_add_u32 s64, s64, s52
  s_waitcnt lgkmcnt(0)
  s_add_u32 m0, s57, 152576
  s_nop 0
  buffer_load_dwordx4 v20, s[36:39], s56 offen  lds
  s_add_u32 m0, s57, 131072
  s_nop 0
  buffer_load_dwordx4 v23, s[12:15], 0 offen  lds
  s_add_u32 m0, s57, 142336
  s_nop 0
  buffer_load_dwordx4 v20, s[16:19], s56 offen  lds
  s_add_u32 m0, s57, 156672
  s_nop 0
  buffer_load_dwordx4 v21, s[36:39], s56 offen  lds
  s_add_u32 m0, s57, 135168
  s_nop 0
  buffer_load_dwordx4 v24, s[12:15], 0 offen  lds
  s_add_u32 m0, s57, 146432
  s_nop 0
  buffer_load_dwordx4 v21, s[16:19], s56 offen  lds
  s_cmp_ge_u32 s3, 3
  s_cbranch_scc1 Lskip_1
  s_add_u32 m0, s57, 139264
  s_nop 0
  buffer_load_dwordx4 v25, s[12:15], 0 offen  lds
Lskip_1:
  s_cmp_ge_u32 s3, 2
  s_cbranch_scc1 Lskip_2
  s_add_u32 m0, s57, 160768
  s_nop 0
  buffer_load_dwordx4 v22, s[36:39], s56 offen  lds
  s_add_u32 m0, s57, 150528
  s_nop 0
  buffer_load_dwordx4 v22, s[16:19], s56 offen  lds
Lskip_2:
  v_lshrrev_b32 v26, 4, v0
  v_mul_u32_u24 v27, 52, v26
  v_lshrrev_b32 v27, 8, v27
  v_mul_u32_u24 v30, 5, v27
  v_sub_u32 v28, v26, v30
  v_mul_u32_u24 v30, 24, v27
  v_min_u32 v30, 40, v30
  v_and_b32 v29, 15, v0
  v_lshl_add_u32 v31, v28, 4, v29
  v_lshlrev_b32 v26, 3, v31
  s_mul_i32 s52, s5, 640
  buffer_load_dwordx2 v[168:169], v26, s[20:23], s52 offen
  s_add_u32 m0, s58, 0
  s_nop 0
  buffer_load_dwordx4 v114, s[8:11], s81 offen  lds
  buffer_load_dwordx4 v115, s[8:11], s81 offen offset:1024  lds
  s_add_u32 m0, s58, 81920
  s_nop 0
  buffer_load_dwordx4 v6, s[32:35], s64 offen offset:0 lds
  buffer_load_dwordx4 v14, s[32:35], s64 offen offset:1024 lds
  s_add_u32 s65, s64, 196608
  s_cmp_ge_u32 s65, 1966080
  s_cselect_b32 s52, 1966080, 0
  s_sub_u32 s65, s65, s52
  s_add_u32 s66, s65, 196608
  s_cmp_ge_u32 s66, 1966080
  s_cselect_b32 s52, 1966080, 0
  s_sub_u32 s66, s66, s52
  s_add_u32 s67, s66, 196608
  s_cmp_ge_u32 s67, 1966080
  s_cselect_b32 s52, 1966080, 0
  s_sub_u32 s67, s67, s52
  s_add_u32 s68, s67, 196608
  s_cmp_ge_u32 s68, 1966080
  s_cselect_b32 s52, 1966080, 0
  s_sub_u32 s68, s68, s52
  s_add_u32 s69, s68, 196608
  s_cmp_ge_u32 s69, 1966080
  s_cselect_b32 s52, 1966080, 0
  s_sub_u32 s69, s69, s52
  s_add_u32 s70, s69, 196608
  s_cmp_ge_u32 s70, 1966080
  s_cselect_b32 s52, 1966080, 0
  s_sub_u32 s70, s70, s52
  s_add_u32 s71, s70, 196608
  s_cmp_ge_u32 s71, 1966080
  s_cselect_b32 s52, 1966080, 0
  s_sub_u32 s71, s71, s52
  s_add_u32 s72, s71, 196608
  s_cmp_ge_u32 s72, 1966080
  s_cselect_b32 s52, 1966080, 0
  s_sub_u32 s72, s72, s52
  s_add_u32 s73, s72, 196608
  s_cmp_ge_u32 s73, 1966080
  s_cselect_b32 s52, 1966080, 0
  s_sub_u32 s73, s73, s52
  v_bfe_u32 v52, v1, 3, 2
  v_add_u32 v53, s6, v52
  v_add_u32 v54, 0, v53
  v_subrev_u32 v55, 10, v54
  v_min_u32 v54, v54, v55
  v_lshlrev_b32 v54, 7, v54
  v_lshl_add_u32 v154, v38, 4, v54
  v_add_u32 v54, 4, v53
  v_subrev_u32 v55, 10, v54
  v_min_u32 v54, v54, v55
  v_lshlrev_b32 v54, 7, v54
  v_lshl_add_u32 v155, v38, 4, v54
  v_add_u32 v54, 8, v53
  v_subrev_u32 v55, 10, v54
  v_min_u32 v54, v54, v55
  v_lshlrev_b32 v54, 7, v54
  v_lshl_add_u32 v156, v38, 4, v54
  v_lshrrev_b32 v55, 1, v52
  v_lshl_add_u32 v156, v55, 16, v156
  v_lshrrev_b32 v26, 2, v29
  v_add_u32 v26, v26, v30
  v_mul_u32_u24 v26, 160, v26
  v_and_b32 v27, 3, v0
  v_lshl_add_u32 v26, v27, 3, v26
  v_lshl_add_u32 v26, v28, 5, v26
  v_add_u32 v158, 131072, v26
  v_mul_u32_u24 v26, 144, v31
  v_lshl_add_u32 v26, v30, 1, v26
  v_add_u32 v159, 65536, v26
  v_lshrrev_b32 v26, 3, v0
  v_mul_u32_u24 v54, 144, v26
  v_lshl_add_u32 v54, v38, 4, v54
  v_add_u32 v160, 65536, v54
  v_mul_u32_u24 v54, 4224, v26
  v_lshl_add_u32 v3, v38, 4, v54
  v_lshrrev_b32 v26, 5, v1
  v_lshlrev_b32 v26, 4, v26
  v_bfe_u32 v54, v1, 2, 3
  v_add_u32 v26, v26, v54
  v_mul_u32_u24 v26, 160, v26
  s_and_b32 s52, s3, 1
  s_mul_i32 s52, s52, 5120
  s_add_u32 s52, s52, 152576
  s_lshr_b32 s53, s3, 1
  s_lshl_b32 s53, s53, 6
  v_add_u32 v26, s52, v26
  v_lshl_add_u32 v162, v27, 3, v26
  v_lshl_add_u32 v161, v27, 4, v26
  v_add_u32 v161, s53, v161
  v_lshrrev_b32 v26, 5, v1
  v_lshlrev_b32 v26, 10, v26
  v_bfe_u32 v54, v1, 2, 2
  v_lshl_add_u32 v26, v54, 7, v26
  v_bfe_u32 v54, v1, 3, 1
  v_lshlrev_b32 v54, 6, v54
  v_xor_b32 v54, s53, v54
  v_add_u32 v26, v26, v54
  v_bfe_u32 v54, v1, 4, 1
  v_lshl_add_u32 v26, v54, 5, v26
  v_lshl_add_u32 v10, v27, 3, v26
  v_add_u32 v11, 65536, v10
  v_add_u32 v12, 131072, v10
  v_lshrrev_b32 v26, 5, v1
  v_lshlrev_b32 v26, 8, v26
  v_lshl_add_u32 v26, v29, 4, v26
  v_mul_u32_u24 v54, 49152, v54
  v_add_u32 v13, v26, v54
  s_mul_i32 s74, s4, 196608
  s_and_b32 s52, s3, 1
  s_mul_i32 s52, s52, 98304
  s_add_u32 s74, s74, s52
  s_mul_i32 s52, s5, 6144
  s_add_u32 s74, s74, s52
  s_lshl_b32 s53, s53, 4
  s_add_u32 s74, s74, s53
  s_add_u32 s74, s74, 9437184
  s_add_u32 s75, s74, 2048
  s_add_u32 s76, s74, 4096
  s_mul_i32 s77, s5, 337920
  s_lshl_b32 s52, s4, 7
  s_add_u32 s77, s77, s52
  s_mul_i32 s61, s5, 80
  s_sub_u32 s52, s4, 12
  s_min_u32 s52, s52, s4
  s_lshl_b32 s52, s52, 2
  s_add_u32 s61, s61, s52
  s_add_u32 s61, s61, s3
  s_sub_u32 s52, s4, 4
  s_lshl_b32 s53, s52, 2
  s_add_u32 s53, s53, s3
  s_lshl_b32 s53, s53, 1
  s_mul_i32 s54, s5, 80
  s_add_u32 s53, s53, s54
  s_cmp_lt_u32 s52, 10
  s_cselect_b32 s53, s53, 0x4000
  s_cmp_ge_u32 s52, 12
  s_cselect_b32 s61, s61, s53
  s_cselect_b32 s54, 0, 128
  s_mov_b32 s62, 0xbfb8aa3b
  s_mov_b32 s63, 0xbfb8aa3b
  s_mov_b32 s79, 200000
  v_cmp_gt_u32 vcc, 32, v1
  v_mov_b32 v26, 0x7ff00000
  v_lshlrev_b32 v54, 2, v1
  v_cndmask_b32 v7, v26, v54, vcc
  v_and_b32 v26, 31, v1
  v_lshlrev_b32 v26, 7, v26
  v_lshrrev_b32 v54, 5, v1
  v_lshrrev_b32 v55, 1, v29
  v_xor_b32 v54, v54, v55
  v_lshl_add_u32 v26, v54, 4, v26
  s_and_b32 s52, s3, 1
  s_lshl_b32 s52, s52, 12
  v_add_u32 v116, s52, v26
  v_xor_b32 v117, 32, v116
  v_xor_b32 v118, 64, v116
  v_xor_b32 v119, 96, v116
  v_add_u32 v120, 65536, v116
  v_add_u32 v121, 65536, v117
  v_add_u32 v122, 65536, v118
  v_add_u32 v123, 65536, v119
  v_lshrrev_b32 v26, 4, v1
  s_mul_i32 s52, s5, 10
  v_lshlrev_b32 v72, 7, v29
  v_add_u32 v72, s58, v72
  s_add_u32 s53, s52, 0
  v_add_u32 v54, s53, v26
  v_lshrrev_b32 v73, 3, v54
  v_subrev_u32 v73, s6, v73
  v_add_u32 v74, 10, v73
  v_min_u32 v73, v73, v74
  v_and_b32 v54, 7, v54
  v_xor_b32 v54, v54, v55
  v_lshl_add_u32 v54, v54, 4, v72
  v_lshl_add_u32 v124, v73, 13, v54
  s_add_u32 s53, s52, 4
  v_add_u32 v54, s53, v26
  v_lshrrev_b32 v73, 3, v54
  v_subrev_u32 v73, s6, v73
  v_add_u32 v74, 10, v73
  v_min_u32 v73, v73, v74
  v_and_b32 v54, 7, v54
  v_xor_b32 v54, v54, v55
  v_lshl_add_u32 v54, v54, 4, v72
  v_lshl_add_u32 v125, v73, 13, v54
  s_add_u32 s53, s52, 8
  v_lshrrev_b32 v54, 1, v26
  v_add_u32 v54, s53, v54
  v_lshrrev_b32 v73, 3, v54
  v_subrev_u32 v73, s6, v73
  v_add_u32 v74, 10, v73
  v_min_u32 v73, v73, v74
  v_and_b32 v54, 7, v54
  v_xor_b32 v54, v54, v55
  v_lshl_add_u32 v54, v54, 4, v72
  v_lshl_add_u32 v126, v73, 13, v54
  v_and_b32 v26, 1, v26
  v_lshl_add_u32 v126, v26, 3, v126
  s_lshl_b32 s52, s5, 2
  s_add_u32 s52, s52, s3
  s_and_b32 s53, s52, 7
  s_lshl_b32 s52, s52, 8
  v_xor_b32 v26, s53, v38
  v_lshlrev_b32 v26, 4, v26
  v_lshrrev_b32 v54, 5, v1
  v_lshl_add_u32 v26, v54, 7, v26
  v_add_u32 v26, s52, v26
  v_lshl_add_u32 v127, v52, 13, v26
  v_and_b32 v54, 1, v52
  v_lshl_add_u32 v26, v54, 13, v26
  v_add_u32 v128, 65536, v26
  s_mul_i32 s52, s5, 48
  s_lshl_b32 s53, s4, 1
  s_add_u32 s52, s52, s53
  s_and_b32 s53, s3, 1
  s_add_u32 s52, s52, s53
  s_mul_i32 s52, s52, 5120
  s_add_u32 s52, s52, 7340032
  s_cmp_lt_u32 s4, 24
  s_cselect_b32 s52, s52, 0x7f000000
  s_and_b32 s53, s3, 2
  s_lshl_b32 s78, s53, 10
  s_add_u32 s78, s78, s52
  s_add_u32 s80, s52, 4096
  s_cmp_eq_u32 s53, 0
  s_cselect_b32 s80, s80, 0x7f000000
  s_add_u32 s81, s81, 128
  s_cmp_ge_u32 s81, s7
  s_cselect_b32 m0, 1280, 0
  s_sub_u32 s81, s81, m0
  s_add_u32 m0, s58, 8192
  s_nop 0
  buffer_load_dwordx4 v114, s[8:11], s81 offen  lds
  buffer_load_dwordx4 v115, s[8:11], s81 offen offset:1024  lds
  s_add_u32 m0, s58, 90112
  s_nop 0
  buffer_load_dwordx4 v6, s[32:35], s65 offen offset:0 lds
  buffer_load_dwordx4 v14, s[32:35], s65 offen offset:1024 lds
  s_add_u32 s81, s81, 128
  s_cmp_ge_u32 s81, s7
  s_cselect_b32 m0, 1280, 0
  s_sub_u32 s81, s81, m0
  s_add_u32 m0, s58, 16384
  s_nop 0
  buffer_load_dwordx4 v114, s[8:11], s81 offen  lds
  buffer_load_dwordx4 v115, s[8:11], s81 offen offset:1024  lds
  s_add_u32 m0, s58, 98304
  s_nop 0
  buffer_load_dwordx4 v6, s[32:35], s66 offen offset:0 lds
  buffer_load_dwordx4 v14, s[32:35], s66 offen offset:1024 lds
  s_lshl_b32 s52, s5, 8
  s_lshl_b32 s53, s4, 8
  s_add_u32 s52, s52, 32768
  s_add_u32 s53, s53, 40960
  buffer_load_dword v170, off, s[48:51], s52 sc1
  buffer_load_dword v171, off, s[48:51], s53 sc1
  s_cmp_eq_u32 s3, 0
  s_cbranch_scc1 Ltp0
  s_cmp_eq_u32 s3, 1
  s_cbranch_scc1 Ltp1
  s_cmp_eq_u32 s3, 2
  s_cbranch_scc1 Ltp2
  s_branch Ltp3
Ltback:
  s_waitcnt vmcnt(14)
  s_barrier
  ds_read_b64_tr_b16 v[184:185], v158 offset:0
  ds_read_b64_tr_b16 v[198:199], v158 offset:11264
  ds_read_b64_tr_b16 v[186:187], v158 offset:640
  ds_read_b64_tr_b16 v[200:201], v158 offset:11904
  ds_read_b64_tr_b16 v[188:189], v158 offset:1280
  ds_read_b64_tr_b16 v[202:203], v158 offset:12544
  ds_read_b64_tr_b16 v[190:191], v158 offset:1920
  ds_read_b64_tr_b16 v[204:205], v158 offset:13184
  ds_read_b64_tr_b16 v[192:193], v158 offset:2560
  ds_read_b64_tr_b16 v[206:207], v158 offset:13824
  ds_read_b64_tr_b16 v[194:195], v158 offset:3200
  ds_read_b64_tr_b16 v[208:209], v158 offset:14464
  ds_read_b64_tr_b16 v[196:197], v158 offset:3840
  ds_read_b64_tr_b16 v[172:173], v161 offset:0
  ds_read_b64_tr_b16 v[174:175], v161 offset:1280
  ds_read_b64_tr_b16 v[176:177], v161 offset:8
  ds_read_b64_tr_b16 v[178:179], v161 offset:1288
  ds_read_b64_tr_b16 v[180:181], v162 offset:128
  ds_read_b64_tr_b16 v[182:183], v162 offset:1408
  s_mov_b32 s52, 0xffff
  v_and_b32 v163, 0xffff, v168
  v_bfi_b32 v164, s52, v169, v168
  v_and_b32 v165, 0xffff0000, v169
  v_alignbit_b32 v166, v168, v168, 16
  v_alignbit_b32 v167, v169, v169, 16
  s_waitcnt lgkmcnt(15)
  v_dot2_f32_bf16 v222, v186, v163, 0
  v_dot2_f32_bf16 v223, v186, v166, 0
  v_dot2_f32_bf16 v222, v185, v164, v222
  v_dot2_f32_bf16 v223, v185, v167, v223
  v_dot2_f32_bf16 v222, v184, v165, v222
  v_lshlrev_b32 v224, 16, v198
  v_and_b32 v225, 0xffff0000, v198
  v_dot2_f32_bf16 v230, v187, v163, 0
  v_dot2_f32_bf16 v231, v187, v166, 0
  v_dot2_f32_bf16 v230, v186, v164, v230
  v_dot2_f32_bf16 v231, v186, v167, v231
  v_dot2_f32_bf16 v230, v185, v165, v230
  v_lshlrev_b32 v232, 16, v199
  v_and_b32 v233, 0xffff0000, v199
  v_pk_mul_f32 v[222:223], v[222:223], v[224:225]
  v_cvt_pk_bf16_f32 v210, v222, v223
  s_add_u32 s81, s81, 128
  s_cmp_ge_u32 s81, s7
  s_cselect_b32 m0, 1280, 0
  s_sub_u32 s81, s81, m0
  s_add_u32 m0, s58, 24576
  s_nop 0
  buffer_load_dwordx4 v114, s[8:11], s81 offen  lds
  buffer_load_dwordx4 v115, s[8:11], s81 offen offset:1024  lds
  s_waitcnt lgkmcnt(14)
  v_dot2_f32_bf16 v222, v188, v163, 0
  v_dot2_f32_bf16 v223, v188, v166, 0
  v_dot2_f32_bf16 v222, v187, v164, v222
  v_dot2_f32_bf16 v223, v187, v167, v223
  v_dot2_f32_bf16 v222, v186, v165, v222
  v_lshlrev_b32 v224, 16, v200
  v_and_b32 v225, 0xffff0000, v200
  v_pk_mul_f32 v[230:231], v[230:231], v[232:233]
  v_cvt_pk_bf16_f32 v211, v230, v231
  v_dot2_f32_bf16 v230, v189, v163, 0
  v_dot2_f32_bf16 v231, v189, v166, 0
  v_dot2_f32_bf16 v230, v188, v164, v230
  v_dot2_f32_bf16 v231, v188, v167, v231
  v_dot2_f32_bf16 v230, v187, v165, v230
  v_lshlrev_b32 v232, 16, v201
  v_and_b32 v233, 0xffff0000, v201
  v_pk_mul_f32 v[222:223], v[222:223], v[224:225]
  v_cvt_pk_bf16_f32 v212, v222, v223
  s_add_u32 m0, s58, 106496
  s_nop 0
  buffer_load_dwordx4 v6, s[32:35], s67 offen offset:0 lds
  buffer_load_dwordx4 v14, s[32:35], s67 offen offset:1024 lds
  s_waitcnt lgkmcnt(12)
  v_dot2_f32_bf16 v222, v190, v163, 0
  v_dot2_f32_bf16 v223, v190, v166, 0
  v_dot2_f32_bf16 v222, v189, v164, v222
  v_dot2_f32_bf16 v223, v189, v167, v223
  v_dot2_f32_bf16 v222, v188, v165, v222
  v_lshlrev_b32 v224, 16, v202
  v_and_b32 v225, 0xffff0000, v202
  v_pk_mul_f32 v[230:231], v[230:231], v[232:233]
  v_cvt_pk_bf16_f32 v213, v230, v231
  ds_write_b128 v159, v[210:213] offset:0
  v_dot2_f32_bf16 v230, v191, v163, 0
  v_dot2_f32_bf16 v231, v191, v166, 0
  v_dot2_f32_bf16 v230, v190, v164, v230
  v_dot2_f32_bf16 v231, v190, v167, v231
  v_dot2_f32_bf16 v230, v189, v165, v230
  v_lshlrev_b32 v232, 16, v203
  v_and_b32 v233, 0xffff0000, v203
  v_pk_mul_f32 v[222:223], v[222:223], v[224:225]
  v_cvt_pk_bf16_f32 v214, v222, v223
  s_add_u32 s81, s81, 128
  s_cmp_ge_u32 s81, s7
  s_cselect_b32 m0, 1280, 0
  s_sub_u32 s81, s81, m0
  s_add_u32 m0, s58, 32768
  s_nop 0
  buffer_load_dwordx4 v114, s[8:11], s81 offen  lds
  buffer_load_dwordx4 v115, s[8:11], s81 offen offset:1024  lds
  s_waitcnt lgkmcnt(11)
  v_dot2_f32_bf16 v222, v192, v163, 0
  v_dot2_f32_bf16 v223, v192, v166, 0
  v_dot2_f32_bf16 v222, v191, v164, v222
  v_dot2_f32_bf16 v223, v191, v167, v223
  v_dot2_f32_bf16 v222, v190, v165, v222
  v_lshlrev_b32 v224, 16, v204
  v_and_b32 v225, 0xffff0000, v204
  v_pk_mul_f32 v[230:231], v[230:231], v[232:233]
  v_cvt_pk_bf16_f32 v215, v230, v231
  v_dot2_f32_bf16 v230, v193, v163, 0
  v_dot2_f32_bf16 v231, v193, v166, 0
  v_dot2_f32_bf16 v230, v192, v164, v230
  v_dot2_f32_bf16 v231, v192, v167, v231
  v_dot2_f32_bf16 v230, v191, v165, v230
  v_lshlrev_b32 v232, 16, v205
  s_branch Lts0
Ltp0:
  s_branch Ltp4
Lts0:
  v_and_b32 v233, 0xffff0000, v205
  v_pk_mul_f32 v[222:223], v[222:223], v[224:225]
  v_cvt_pk_bf16_f32 v216, v222, v223
  s_add_u32 m0, s58, 114688
  s_nop 0
  buffer_load_dwordx4 v6, s[32:35], s68 offen offset:0 lds
  buffer_load_dwordx4 v14, s[32:35], s68 offen offset:1024 lds
  s_waitcnt lgkmcnt(9)
  v_dot2_f32_bf16 v222, v194, v163, 0
  v_dot2_f32_bf16 v223, v194, v166, 0
  v_dot2_f32_bf16 v222, v193, v164, v222
  v_dot2_f32_bf16 v223, v193, v167, v223
  v_dot2_f32_bf16 v222, v192, v165, v222
  v_lshlrev_b32 v224, 16, v206
  v_and_b32 v225, 0xffff0000, v206
  v_pk_mul_f32 v[230:231], v[230:231], v[232:233]
  v_cvt_pk_bf16_f32 v217, v230, v231
  ds_write_b128 v159, v[214:217] offset:16
  v_dot2_f32_bf16 v230, v195, v163, 0
  v_dot2_f32_bf16 v231, v195, v166, 0
  v_dot2_f32_bf16 v230, v194, v164, v230
  v_dot2_f32_bf16 v231, v194, v167, v231
  v_dot2_f32_bf16 v230, v193, v165, v230
  v_lshlrev_b32 v232, 16, v207
  v_and_b32 v233, 0xffff0000, v207
  v_pk_mul_f32 v[222:223], v[222:223], v[224:225]
  v_cvt_pk_bf16_f32 v218, v222, v223
  s_add_u32 s81, s81, 128
  s_cmp_ge_u32 s81, s7
  s_cselect_b32 m0, 1280, 0
  s_sub_u32 s81, s81, m0
  s_add_u32 m0, s58, 40960
  s_nop 0
  buffer_load_dwordx4 v114, s[8:11], s81 offen  lds
  buffer_load_dwordx4 v115, s[8:11], s81 offen offset:1024  lds
  s_waitcnt lgkmcnt(8)
  v_dot2_f32_bf16 v222, v196, v163, 0
  v_dot2_f32_bf16 v223, v196, v166, 0
  v_dot2_f32_bf16 v222, v195, v164, v222
  v_dot2_f32_bf16 v223, v195, v167, v223
  v_dot2_f32_bf16 v222, v194, v165, v222
  v_lshlrev_b32 v224, 16, v208
  v_and_b32 v225, 0xffff0000, v208
  v_pk_mul_f32 v[230:231], v[230:231], v[232:233]
  v_cvt_pk_bf16_f32 v219, v230, v231
  v_dot2_f32_bf16 v230, v197, v163, 0
  v_dot2_f32_bf16 v231, v197, v166, 0
  v_dot2_f32_bf16 v230, v196, v164, v230
  v_dot2_f32_bf16 v231, v196, v167, v231
  v_dot2_f32_bf16 v230, v195, v165, v230
  v_lshlrev_b32 v232, 16, v209
  v_and_b32 v233, 0xffff0000, v209
  v_pk_mul_f32 v[222:223], v[222:223], v[224:225]
  v_cvt_pk_bf16_f32 v220, v222, v223
  s_add_u32 m0, s58, 122880
  s_nop 0
  buffer_load_dwordx4 v6, s[32:35], s69 offen offset:0 lds
  buffer_load_dwordx4 v14, s[32:35], s69 offen offset:1024 lds
  v_pk_mul_f32 v[230:231], v[230:231], v[232:233]
  v_cvt_pk_bf16_f32 v221, v230, v231
  ds_write_b128 v159, v[218:221] offset:32
  s_waitcnt vmcnt(22) lgkmcnt(0)
  s_barrier
  ds_read_b128 v[184:187], v160 offset:0
  ds_read_b128 v[188:191], v160 offset:4608
  ds_read_b128 v[192:195], v160 offset:9216
  ds_read_b64_tr_b16 v[48:49], v11 offset:16384
  ds_read_b64_tr_b16 v[50:51], v11 offset:16896
  ds_read_b128 a[0:3], v116 offset:0
  ds_read_b64_tr_b16 v[52:53], v11 offset:18432
  ds_read_b64_tr_b16 v[54:55], v11 offset:18944
  ds_read_b128 a[4:7], v117 offset:0
  ds_read_b64_tr_b16 v[56:57], v11 offset:20480
  ds_read_b64_tr_b16 v[58:59], v11 offset:20992
  ds_read_b128 a[8:11], v118 offset:0
  ds_read_b64_tr_b16 v[60:61], v11 offset:22528
  ds_read_b64_tr_b16 v[62:63], v11 offset:23040
  ds_read_b128 a[12:15], v119 offset:0
  s_waitcnt lgkmcnt(0)
  s_waitcnt vmcnt(18)
  s_barrier
  ds_read_b64_tr_b16 v[64:65], v11 offset:24576
  ds_read_b64_tr_b16 v[66:67], v11 offset:25088
  ds_read_b128 a[16:19], v116 offset:8192
  v_mfma_f32_32x32x16_bf16 v[16:31], v[48:51], a[0:3], 0
  ds_read_b64_tr_b16 v[68:69], v11 offset:26624
  ds_read_b64_tr_b16 v[70:71], v11 offset:27136
  ds_read_b128 a[20:23], v117 offset:8192
  s_add_u32 s81, s81, 128
  s_cmp_ge_u32 s81, s7
  s_cselect_b32 m0, 1280, 0
  s_sub_u32 s81, s81, m0
  s_add_u32 m0, s58, 49152
  s_nop 0
  buffer_load_dwordx4 v114, s[8:11], s81 offen  lds
  v_and_b32 v85, 15, v1
  v_mfma_f32_32x32x16_bf16 v[16:31], v[52:55], a[4:7], v[16:31]
  ds_read_b64_tr_b16 v[72:73], v11 offset:28672
  ds_read_b64_tr_b16 v[74:75], v11 offset:29184
  ds_read_b128 a[24:27], v118 offset:8192
  buffer_load_dwordx4 v115, s[8:11], s81 offen offset:1024  lds
  s_add_u32 m0, s58, 131072
  s_nop 0
  buffer_load_dwordx4 v6, s[32:35], s70 offen offset:0 lds
  buffer_load_dwordx4 v14, s[32:35], s70 offen offset:1024 lds
  s_mul_i32 s0, s3, 4352
  v_mfma_f32_32x32x16_bf16 v[16:31], v[56:59], a[8:11], v[16:31]
  ds_read_b64_tr_b16 v[76:77], v11 offset:30720
  ds_read_b64_tr_b16 v[78:79], v11 offset:31232
  ds_read_b128 a[28:31], v119 offset:8192
  buffer_store_dwordx4 v[172:175], v2, s[48:51], s78 offen sc1
  buffer_store_dwordx4 v[176:179], v2, s[48:51], s78 offen offset:1024 sc1
  buffer_store_dwordx4 v[180:183], v2, s[48:51], s80 offen sc1
  s_add_u32 s55, s77, 1048576
  v_min_u32 v80, 23, v1
  v_mfma_f32_32x32x16_bf16 v[16:31], v[60:63], a[12:15], v[16:31]
  s_waitcnt vmcnt(21)
  s_barrier
  ds_read_b64_tr_b16 v[48:49], v11 offset:32768
  ds_read_b64_tr_b16 v[50:51], v11 offset:33280
  ds_read_b128 a[32:35], v116 offset:16384
  buffer_store_dwordx4 v[184:187], v3, s[48:51], s55 offen sc1
  s_add_u32 s55, s77, 1183744
  buffer_store_dwordx4 v[188:191], v3, s[48:51], s55 offen sc1
  s_add_u32 s55, s77, 1318912
  s_cmp_lt_u32 s3, 2
  s_cselect_b32 s55, s55, 0x7f000000
  s_waitcnt lgkmcnt(12)
  v_mfma_f32_32x32x16_bf16 v[16:31], v[64:67], a[16:19], v[16:31]
  ds_read_b64_tr_b16 v[52:53], v11 offset:34816
  ds_read_b64_tr_b16 v[54:55], v11 offset:35328
  ds_read_b128 a[36:39], v117 offset:16384
  buffer_store_dwordx4 v[192:195], v3, s[48:51], s55 offen sc1
  s_add_u32 s81, s81, 128
  s_cmp_ge_u32 s81, s7
  s_cselect_b32 m0, 1280, 0
  s_sub_u32 s81, s81, m0
  s_add_u32 m0, s58, 57344
  s_waitcnt lgkmcnt(12)
  v_mfma_f32_32x32x16_bf16 v[16:31], v[68:71], a[20:23], v[16:31]
  ds_read_b64_tr_b16 v[56:57], v11 offset:36864
  ds_read_b64_tr_b16 v[58:59], v11 offset:37376
  ds_read_b128 a[40:43], v118 offset:16384
  buffer_load_dwordx4 v114, s[8:11], s81 offen  lds
  buffer_load_dwordx4 v115, s[8:11], s81 offen offset:1024  lds
  s_add_u32 m0, s58, 139264
  s_nop 0
  buffer_load_dwordx4 v6, s[32:35], s71 offen offset:0 lds
  s_waitcnt lgkmcnt(12)
  v_mfma_f32_32x32x16_bf16 v[16:31], v[72:75], a[24:27], v[16:31]
  ds_read_b64_tr_b16 v[60:61], v11 offset:38912
  ds_read_b64_tr_b16 v[62:63], v11 offset:39424
  ds_read_b128 a[44:47], v119 offset:16384
  buffer_load_dwordx4 v14, s[32:35], s71 offen offset:1024 lds
  v_lshl_add_u32 v0, v80, 2, s0
  s_add_u32 s36, s0, 96
  s_lshl_b32 s23, s61, 12
  v_and_b32 v80, 3, v1
  v_lshrrev_b32 v81, 4, v1
  s_waitcnt lgkmcnt(12)
  v_mfma_f32_32x32x16_bf16 v[16:31], v[76:79], a[28:31], v[16:31]
  s_waitcnt vmcnt(22)
  s_barrier
  ds_read_b64_tr_b16 v[64:65], v11 offset:40960
  ds_read_b64_tr_b16 v[66:67], v11 offset:41472
  ds_read_b128 a[48:51], v116 offset:24576
  s_add_u32 s81, s81, 128
  s_cmp_ge_u32 s81, s7
  s_cselect_b32 m0, 1280, 0
  s_sub_u32 s81, s81, m0
  s_add_u32 m0, s58, 65536
  v_bfe_u32 v82, v1, 2, 2
  s_waitcnt lgkmcnt(12)
  v_mfma_f32_32x32x16_bf16 v[16:31], v[48:51], a[32:35], v[16:31]
  ds_read_b64_tr_b16 v[68:69], v11 offset:43008
  ds_read_b64_tr_b16 v[70:71], v11 offset:43520
  ds_read_b128 a[52:55], v117 offset:24576
  buffer_load_dwordx4 v114, s[8:11], s81 offen  lds
  buffer_load_dwordx4 v115, s[8:11], s81 offen offset:1024  lds
  s_add_u32 m0, s58, 147456
  s_nop 0
  buffer_load_dwordx4 v6, s[32:35], s72 offen offset:0 lds
  s_waitcnt lgkmcnt(12)
  v_mfma_f32_32x32x16_bf16 v[16:31], v[52:55], a[36:39], v[16:31]
  ds_read_b64_tr_b16 v[72:73], v11 offset:45056
  ds_read_b64_tr_b16 v[74:75], v11 offset:45568
  ds_read_b128 a[56:59], v118 offset:24576
  buffer_load_dwordx4 v14, s[32:35], s72 offen offset:1024 lds
  v_add_u32 v83, v80, v81
  v_lshlrev_b32 v83, 5, v83
  v_lshl_add_u32 v83, v82, 3, v83
  v_add_u32 v109, s0, v83
  v_sub_u32 v83, v80, v82
  s_waitcnt lgkmcnt(12)
  v_mfma_f32_32x32x16_bf16 v[16:31], v[56:59], a[40:43], v[16:31]
  ds_read_b64_tr_b16 v[76:77], v11 offset:47104
  ds_read_b64_tr_b16 v[78:79], v11 offset:47616
  ds_read_b128 a[60:63], v119 offset:24576
  v_lshlrev_b32 v84, 2, v81
  v_sub_u32 v83, v83, v84
  s_add_u32 s1, s0, 192
  s_add_u32 s1, s1, s54
  v_lshl_add_u32 v110, v83, 3, s1
  s_add_u32 s1, s0, 96
  v_lshl_add_u32 v111, v1, 1, s1
  s_waitcnt lgkmcnt(12)
  v_mfma_f32_32x32x16_bf16 v[16:31], v[60:63], a[44:47], v[16:31]
  s_waitcnt vmcnt(22)
  s_barrier
  ds_read_b64_tr_b16 v[48:49], v11 offset:49152
  ds_read_b64_tr_b16 v[50:51], v11 offset:49664
  ds_read_b128 a[64:67], v116 offset:32768
  s_add_u32 s81, s81, 128
  s_cmp_ge_u32 s81, s7
  s_cselect_b32 m0, 1280, 0
  s_sub_u32 s81, s81, m0
  s_add_u32 m0, s58, 73728
  s_mul_i32 s1, s3, 4480
  s_waitcnt lgkmcnt(12)
  v_mfma_f32_32x32x16_bf16 v[16:31], v[64:67], a[48:51], v[16:31]
  ds_read_b64_tr_b16 v[52:53], v11 offset:51200
  ds_read_b64_tr_b16 v[54:55], v11 offset:51712
  ds_read_b128 a[68:71], v117 offset:32768
  buffer_load_dwordx4 v114, s[8:11], s81 offen  lds
  buffer_load_dwordx4 v115, s[8:11], s81 offen offset:1024  lds
  s_add_u32 m0, s58, 155648
  s_nop 0
  buffer_load_dwordx4 v6, s[32:35], s73 offen offset:0 lds
  s_waitcnt lgkmcnt(12)
  v_mfma_f32_32x32x16_bf16 v[16:31], v[68:71], a[52:55], v[16:31]
  ds_read_b64_tr_b16 v[56:57], v11 offset:53248
  ds_read_b64_tr_b16 v[58:59], v11 offset:53760
  ds_read_b128 a[72:75], v118 offset:32768
  buffer_load_dwordx4 v14, s[32:35], s73 offen offset:1024 lds
  buffer_load_dwordx4 v[130:133], v154, s[40:43], 0 offen
  buffer_load_dwordx4 v[134:137], v155, s[40:43], 0 offen
  s_add_u32 s1, s1, 17414
  s_waitcnt lgkmcnt(12)
  v_mfma_f32_32x32x16_bf16 v[16:31], v[72:75], a[56:59], v[16:31]
  ds_read_b64_tr_b16 v[60:61], v11 offset:55296
  ds_read_b64_tr_b16 v[62:63], v11 offset:55808
  ds_read_b128 a[76:79], v119 offset:32768
  buffer_load_dwordx4 v[138:141], v156, s[40:43], 0 offen
  v_lshl_add_u32 v112, v1, 1, s1
  v_lshl_add_u32 v113, v2, 0, s1
  v_mov_b32 v108, 0
  v_mov_b32 v255, 0
  v_mov_b32 v242, 0
  s_waitcnt lgkmcnt(12)
  v_mfma_f32_32x32x16_bf16 v[16:31], v[76:79], a[60:63], v[16:31]
  s_waitcnt vmcnt(25)
  s_barrier
  ds_read_b64_tr_b16 v[64:65], v11 offset:57344
  ds_read_b64_tr_b16 v[66:67], v11 offset:57856
  ds_read_b128 a[80:83], v116 offset:40960
  s_add_u32 m0, s58, 81792
  s_nop 0
  buffer_load_dwordx4 v6, s[32:35], s64 offen offset:128 lds
  buffer_load_dwordx4 v14, s[32:35], s64 offen offset:1152 lds
  s_add_u32 m0, s58, 89984
  s_waitcnt lgkmcnt(12)
  v_mfma_f32_32x32x16_bf16 v[16:31], v[48:51], a[64:67], v[16:31]
  ds_read_b64_tr_b16 v[68:69], v11 offset:59392
  ds_read_b64_tr_b16 v[70:71], v11 offset:59904
  ds_read_b128 a[84:87], v117 offset:40960
  buffer_load_dwordx4 v6, s[32:35], s65 offen offset:128 lds
  buffer_load_dwordx4 v14, s[32:35], s65 offen offset:1152 lds
  v_mov_b32 v243, 0
  v_mov_b32 v252, 0
  v_mov_b32 v253, 0
  s_waitcnt lgkmcnt(12)
  v_mfma_f32_32x32x16_bf16 v[16:31], v[52:55], a[68:71], v[16:31]
  ds_read_b64_tr_b16 v[72:73], v11 offset:61440
  ds_read_b64_tr_b16 v[74:75], v11 offset:61952
  ds_read_b128 a[88:91], v118 offset:40960
  v_mov_b32 v254, 0
  v_lshlrev_b32 v82, 7, v82
  v_lshl_add_u32 v82, v80, 3, v82
  s_lshl_b32 s1, s3, 5
  s_add_u32 s1, s1, 102400
  v_add_u32 v82, s1, v82
  v_lshl_add_u32 v83, v81, 10, v82
  s_waitcnt lgkmcnt(12)
  v_mfma_f32_32x32x16_bf16 v[16:31], v[56:59], a[72:75], v[16:31]
  ds_read_b64_tr_b16 v[76:77], v11 offset:63488
  ds_read_b64_tr_b16 v[78:79], v11 offset:64000
  ds_read_b128 a[92:95], v119 offset:40960
  v_lshl_add_u32 v82, v81, 9, v82
  v_mul_u32_u24 v84, 1280, v85
  v_lshl_add_u32 v86, v81, 4, v84
  v_lshl_add_u32 v87, v81, 3, v84
  v_accvgpr_write_b32 a250, v83
  v_accvgpr_write_b32 a251, v82
  v_accvgpr_write_b32 a252, v86
  s_waitcnt lgkmcnt(12)
  v_mfma_f32_32x32x16_bf16 v[16:31], v[60:63], a[76:79], v[16:31]
  s_waitcnt vmcnt(25)
  s_barrier
  ds_read_b64_tr_b16 v[48:49], v12 offset:0
  ds_read_b64_tr_b16 v[50:51], v12 offset:512
  ds_read_b128 a[96:99], v116 offset:49152
  s_add_u32 m0, s58, 98176
  s_nop 0
  buffer_load_dwordx4 v6, s[32:35], s66 offen offset:128 lds
  buffer_load_dwordx4 v14, s[32:35], s66 offen offset:1152 lds
  s_add_u32 m0, s58, 106368
  s_waitcnt lgkmcnt(12)
  v_mfma_f32_32x32x16_bf16 v[16:31], v[64:67], a[80:83], v[16:31]
  ds_read_b64_tr_b16 v[52:53], v12 offset:2048
  ds_read_b64_tr_b16 v[54:55], v12 offset:2560
  ds_read_b128 a[100:103], v117 offset:49152
  buffer_load_dwordx4 v6, s[32:35], s67 offen offset:128 lds
  buffer_load_dwordx4 v14, s[32:35], s67 offen offset:1152 lds
  v_accvgpr_write_b32 a253, v87
  s_mul_i32 s1, s3, 20480
  s_add_u32 s56, s56, s1
  s_waitcnt lgkmcnt(12)
  v_mfma_f32_32x32x16_bf16 v[16:31], v[68:71], a[84:87], v[16:31]
  ds_read_b64_tr_b16 v[56:57], v12 offset:4096
  ds_read_b64_tr_b16 v[58:59], v12 offset:4608
  ds_read_b128 a[104:107], v118 offset:49152
  v_and_b32 v9, 31, v1
  v_lshlrev_b32 v9, 7, v9
  s_lshl_b32 s38, s5, 12
  v_lshrrev_b32 v80, 1, v85
  v_and_b32 v81, 1, v1
  v_lshlrev_b32 v81, 3, v81
  v_lshl_add_u32 v8, v80, 7, v81
  s_waitcnt lgkmcnt(12)
  v_mfma_f32_32x32x16_bf16 v[16:31], v[72:75], a[88:91], v[16:31]
  ds_read_b64_tr_b16 v[60:61], v12 offset:6144
  ds_read_b64_tr_b16 v[62:63], v12 offset:6656
  ds_read_b128 a[108:111], v119 offset:49152
  v_min_u32 v80, 23, v1
  v_lshrrev_b32 v81, 3, v80
  v_mul_u32_u24 v81, 24, v81
  v_add_u32 v80, v80, v81
  v_lshl_add_u32 v80, v80, 7, s57
  v_min_u32 v106, 10112, v80
  v_add_u32 v4, 4096, v2
  s_waitcnt lgkmcnt(12)
  v_mfma_f32_32x32x16_bf16 v[16:31], v[76:79], a[92:95], v[16:31]
  s_waitcnt vmcnt(19) lgkmcnt(0)
  s_barrier
  ds_read_b64_tr_b16 v[64:65], v12 offset:8192
  ds_read_b64_tr_b16 v[66:67], v12 offset:8704
  ds_read_b128 a[112:115], v116 offset:57344
  s_add_u32 m0, s58, 114560
  s_nop 0
  buffer_load_dwordx4 v6, s[32:35], s68 offen offset:128 lds
  buffer_load_dwordx4 v14, s[32:35], s68 offen offset:1152 lds
  s_add_u32 m0, s58, 122752
  v_mfma_f32_32x32x16_bf16 v[16:31], v[48:51], a[96:99], v[16:31]
  ds_read_b64_tr_b16 v[68:69], v12 offset:10240
  ds_read_b64_tr_b16 v[70:71], v12 offset:10752
  ds_read_b128 a[116:119], v117 offset:57344
  buffer_load_dwordx4 v6, s[32:35], s69 offen offset:128 lds
  buffer_load_dwordx4 v14, s[32:35], s69 offen offset:1152 lds
  v_add_u32 v5, 8192, v2
  s_lshl_b32 s39, s5, 8
  s_add_u32 s39, s39, 32768
  s_or_b32 s1, s4, s3
  v_mfma_f32_32x32x16_bf16 v[16:31], v[52:55], a[100:103], v[16:31]
  ds_read_b64_tr_b16 v[72:73], v12 offset:12288
  ds_read_b64_tr_b16 v[74:75], v12 offset:12800
  ds_read_b128 a[120:123], v118 offset:57344
  s_cmp_eq_u32 s1, 0
  s_cselect_b32 s39, s39, 0x7f000000
  s_lshl_b32 s6, s4, 8
  s_add_u32 s6, s6, 40960
  s_or_b32 s1, s5, s3
  s_cmp_eq_u32 s1, 0
  s_cselect_b32 s6, s6, 0x7f000000
  s_mul_i32 s37, s5, 245760
  v_mfma_f32_32x32x16_bf16 v[16:31], v[56:59], a[104:107], v[16:31]
  ds_read_b64_tr_b16 v[76:77], v12 offset:14336
  ds_read_b64_tr_b16 v[78:79], v12 offset:14848
  ds_read_b128 a[124:127], v119 offset:57344
  s_mul_i32 s1, s3, 61440
  s_add_u32 s37, s37, s1
  s_add_u32 s37, s37, 7340032
  s_lshl_b32 s13, s4, 12
  s_lshl_b32 s12, s5, 9
  s_add_u32 s13, s13, 262144
  s_add_u32 s12, s12, s13
  s_lshl_b32 s0, s3, 7
  v_mfma_f32_32x32x16_bf16 v[16:31], v[60:63], a[108:111], v[16:31]
  s_waitcnt vmcnt(19) lgkmcnt(0)
  s_barrier
  v_readfirstlane_b32 s59, v170
  v_readfirstlane_b32 s60, v171
  s_mul_i32 s59, s59, 0x2C9277B5
  s_mul_i32 s60, s60, 0x2C9277B5
  s_add_u32 s59, s59, 0xAC564B05
  s_add_u32 s60, s60, 0xAC564B05
  s_lshl_b32 s52, s5, 12
  s_lshl_b32 s53, s4, 7
  s_add_u32 s52, s52, s53
  s_cmp_eq_u32 s3, 0
  s_cselect_b32 s52, s52, 0x7f000000
  v_mov_b32 v107, s59
  buffer_store_dword v107, v7, s[48:51], s52 offen sc1
  ds_read_b64_tr_b16 v[48:49], v12 offset:16384
  ds_read_b64_tr_b16 v[50:51], v12 offset:16896
  ds_read_b128 a[128:131], v120 offset:0
  v_mfma_f32_32x32x16_bf16 v[16:31], v[64:67], a[112:115], v[16:31]
  ds_read_b64_tr_b16 v[52:53], v12 offset:18432
  ds_read_b64_tr_b16 v[54:55], v12 offset:18944
  ds_read_b128 a[132:135], v121 offset:0
  s_add_u32 m0, s58, 130944
  s_nop 0
  buffer_load_dwordx4 v6, s[32:35], s70 offen offset:128 lds
  buffer_load_dwordx4 v14, s[32:35], s70 offen offset:1152 lds
  s_add_u32 m0, s58, 139136
  s_nop 0
  buffer_load_dwordx4 v6, s[32:35], s71 offen offset:128 lds
  v_mfma_f32_32x32x16_bf16 v[16:31], v[68:71], a[116:119], v[16:31]
  ds_read_b64_tr_b16 v[56:57], v12 offset:20480
  ds_read_b64_tr_b16 v[58:59], v12 offset:20992
  ds_read_b128 a[136:139], v122 offset:0
  buffer_load_dwordx4 v14, s[32:35], s71 offen offset:1152 lds
  s_add_u32 s12, s12, s0
  s_add_u32 s13, s13, s57
  s_mul_i32 s1, s4, 196608
  s_mul_i32 s0, s3, 12288
  s_add_u32 s1, s1, s0
  s_add_u32 s1, s1, 9437184
  v_mfma_f32_32x32x16_bf16 v[16:31], v[72:75], a[120:123], v[16:31]
  ds_read_b64_tr_b16 v[60:61], v12 offset:22528
  ds_read_b64_tr_b16 v[62:63], v12 offset:23040
  ds_read_b128 a[140:143], v123 offset:0
  s_add_u32 s0, s3, 1
  s_and_b32 s0, s0, 3
  s_mul_i32 s0, s0, 49152
  s_add_u32 s16, s0, s1
  s_add_u32 s0, s3, 2
  s_and_b32 s0, s0, 3
  s_mul_i32 s0, s0, 49152
  s_add_u32 s17, s0, s1
  v_mfma_f32_32x32x16_bf16 v[16:31], v[76:79], a[124:127], v[16:31]
  s_waitcnt vmcnt(20) lgkmcnt(0)
  s_barrier
  ds_read_b64_tr_b16 v[64:65], v12 offset:24576
  ds_read_b64_tr_b16 v[66:67], v12 offset:25088
  ds_read_b128 a[144:147], v120 offset:8192
  s_add_u32 m0, s58, 147328
  s_nop 0
  buffer_load_dwordx4 v6, s[32:35], s72 offen offset:128 lds
  buffer_load_dwordx4 v14, s[32:35], s72 offen offset:1152 lds
  s_add_u32 s0, s3, 3
  s_and_b32 s0, s0, 3
  v_mfma_f32_32x32x16_bf16 v[16:31], v[48:51], a[128:131], v[16:31]
  ds_read_b64_tr_b16 v[68:69], v12 offset:26624
  ds_read_b64_tr_b16 v[70:71], v12 offset:27136
  ds_read_b128 a[148:151], v121 offset:8192
  s_mul_i32 s0, s0, 49152
  s_add_u32 s18, s0, s1
  s_add_u32 s0, s3, 4
  s_and_b32 s0, s0, 3
  s_mul_i32 s0, s0, 49152
  s_add_u32 s19, s0, s1
  s_lshr_b32 s14, s4, 4
  s_lshl_b32 s14, s14, 3
  v_mfma_f32_32x32x16_bf16 v[16:31], v[52:55], a[132:135], v[16:31]
  ds_read_b64_tr_b16 v[72:73], v12 offset:28672
  ds_read_b64_tr_b16 v[74:75], v12 offset:29184
  ds_read_b128 a[152:155], v122 offset:8192
  s_add_u32 s14, s14, s5
  s_mul_i32 s14, s14, 10240
  s_add_u32 s14, s14, 393216
  s_lshl_b32 s15, s61, 7
  s_add_u32 s15, s15, 475136
  s_mul_i32 s0, s54, 640
  s_sub_u32 s15, s15, s0
  s_cmp_lt_u32 s61, 640
  s_cselect_b32 s15, s15, 0x7f000000
  v_mfma_f32_32x32x16_bf16 v[16:31], v[56:59], a[136:139], v[16:31]
  ds_read_b64_tr_b16 v[76:77], v12 offset:30720
  ds_read_b64_tr_b16 v[78:79], v12 offset:31232
  ds_read_b128 a[156:159], v123 offset:8192
  s_mul_i32 s61, s61, 4224
  s_add_u32 s61, s61, 1048576
  s_mul_i32 s20, s3, 5120
  s_add_u32 s20, s20, 40960
  s_xor_b32 s21, s3, 2
  s_mul_i32 s21, s21, 5120
  s_add_u32 s21, s21, 40960
  s_add_u32 s22, s3, 1
  ds_read_b128 v[142:145], v127
  ds_read_b128 v[146:149], v127 offset:32768
  ds_read_b128 v[150:153], v128
  ds_read_b128 a[240:243], v124
  ds_read_b128 a[244:247], v125
  ds_read_b64 a[248:249], v126
  v_mfma_f32_32x32x16_bf16 v[16:31], v[60:63], a[140:143], v[16:31]
  s_waitcnt vmcnt(15) lgkmcnt(0)
  s_barrier
  ds_read_b64_tr_b16 v[48:49], v11 offset:16384
  ds_read_b64_tr_b16 v[50:51], v11 offset:16896
  s_add_u32 m0, s58, 155520
  v_mfma_f32_32x32x16_bf16 v[16:31], v[64:67], a[144:147], v[16:31]
  ds_read_b64_tr_b16 v[52:53], v11 offset:18432
  ds_read_b64_tr_b16 v[54:55], v11 offset:18944
  buffer_load_dwordx4 v6, s[32:35], s73 offen offset:128 lds
  buffer_load_dwordx4 v14, s[32:35], s73 offen offset:1152 lds
  s_add_u32 m0, s58, 24320
  s_and_b32 s22, s22, 3
  buffer_load_dwordx4 v6, s[32:35], s64 offen offset:256 lds
  v_mfma_f32_32x32x16_bf16 v[16:31], v[68:71], a[148:151], v[16:31]
  ds_read_b64_tr_b16 v[56:57], v11 offset:20480
  ds_read_b64_tr_b16 v[58:59], v11 offset:20992
  buffer_load_dwordx4 v14, s[32:35], s64 offen offset:1280 lds
  ds_write_b32 v0, v242 offset:0
  v_mad_u32_u24 v0, s54, 17, v0
  ds_write_b32 v0, v242 offset:0
  s_mov_b32 m0, s36
  s_mul_i32 s22, s22, 5120
  s_add_u32 s22, s22, 81920
  v_mfma_f32_32x32x16_bf16 v[16:31], v[72:75], a[152:155], v[16:31]
  ds_read_b64_tr_b16 v[60:61], v11 offset:22528
  ds_read_b64_tr_b16 v[62:63], v11 offset:23040
  buffer_load_dwordx4 v2, s[24:27], s23 offen offset:0  lds
  buffer_load_dwordx4 v2, s[24:27], s23 offen offset:1024  lds
  s_lshl4_add_u32 s23, s54, s23
  s_add_u32 m0, s36, s54
  v_dot2_f32_bf16 v154, v142, v130, 0
  v_dot2_f32_bf16 v154, v143, v131, v154
  v_mfma_f32_32x32x16_bf16 v[16:31], v[76:79], a[156:159], v[16:31]
  ds_read_b64_tr_b16 v[64:65], v11 offset:24576
  ds_read_b64_tr_b16 v[66:67], v11 offset:25088
  buffer_load_dwordx4 v2, s[24:27], s23 offen offset:2048  lds
  buffer_load_dwordx4 v2, s[24:27], s23 offen offset:3072  lds
  s_lshr_b32 s23, s23, 12
  s_lshl_b32 s23, s23, 1
  buffer_load_short_d16_hi v255, off, s[28:31], s23 offset:2
  s_waitcnt lgkmcnt(8)
  v_mfma_f32_32x32x16_bf16 v[32:47], v[48:51], a[0:3], 0
  ds_read_b64_tr_b16 v[68:69], v11 offset:26624
  ds_read_b64_tr_b16 v[70:71], v11 offset:27136
  buffer_load_short_d16_hi v108, off, s[28:31], s23
  s_add_u32 m0, s58, 32512
  v_dot2_f32_bf16 v154, v144, v132, v154
  buffer_load_dwordx4 v6, s[32:35], s65 offen offset:256 lds
  v_mfma_f32_32x32x16_bf16 v[32:47], v[52:55], a[4:7], v[32:47]
  ds_read_b64_tr_b16 v[72:73], v11 offset:28672
  ds_read_b64_tr_b16 v[74:75], v11 offset:29184
  buffer_load_dwordx4 v14, s[32:35], s65 offen offset:1280 lds
  v_dot2_f32_bf16 v154, v145, v133, v154
  v_dot2_f32_bf16 v154, v146, v134, v154
  v_dot2_f32_bf16 v154, v147, v135, v154
  v_dot2_f32_bf16 v154, v148, v136, v154
  s_waitcnt lgkmcnt(6)
  v_mfma_f32_32x32x16_bf16 v[32:47], v[56:59], a[8:11], v[32:47]
  ds_read_b64_tr_b16 v[76:77], v11 offset:30720
  ds_read_b64_tr_b16 v[78:79], v11 offset:31232
  v_dot2_f32_bf16 v154, v149, v137, v154
  v_dot2_f32_bf16 v154, v150, v138, v154
  v_dot2_f32_bf16 v154, v151, v139, v154
  v_dot2_f32_bf16 v154, v152, v140, v154
  v_dot2_f32_bf16 v154, v153, v141, v154
  v_mul_f32 v80, s62, v16
  v_mfma_f32_32x32x16_bf16 v[32:47], v[60:63], a[12:15], v[32:47]
  s_waitcnt vmcnt(23)
  s_barrier
  ds_read_b64_tr_b16 v[48:49], v11 offset:32768
  ds_read_b64_tr_b16 v[50:51], v11 offset:33280
  s_add_u32 m0, s58, 40704
  v_add_f32_dpp v154, v154, v154 quad_perm:[1,0,3,2] row_mask:0xf bank_mask:0xf
  buffer_load_dwordx4 v6, s[32:35], s66 offen offset:256 lds
  v_mul_f32 v81, s62, v17
  s_waitcnt lgkmcnt(6)
  v_mfma_f32_32x32x16_bf16 v[32:47], v[64:67], a[16:19], v[32:47]
  ds_read_b64_tr_b16 v[52:53], v11 offset:34816
  ds_read_b64_tr_b16 v[54:55], v11 offset:35328
  buffer_load_dwordx4 v14, s[32:35], s66 offen offset:1280 lds
  v_add_f32_dpp v154, v154, v154 quad_perm:[2,3,0,1] row_mask:0xf bank_mask:0xf
  v_mul_f32 v82, s62, v18
  v_mul_f32 v83, s62, v19
  v_add_f32_dpp v154, v154, v154 row_half_mirror row_mask:0xf bank_mask:0xf
  v_mfma_f32_32x32x16_bf16 v[32:47], v[68:71], a[20:23], v[32:47]
  ds_read_b64_tr_b16 v[56:57], v11 offset:36864
  ds_read_b64_tr_b16 v[58:59], v11 offset:37376
  v_add_f32_dpp v154, v154, v154 row_mirror row_mask:0xf bank_mask:0xf
  v_exp_f32 v80, v80
  v_exp_f32 v81, v81
  v_add_f32_dpp v154, v154, v154 row_bcast:15 row_mask:0xa bank_mask:0xf
  s_waitcnt lgkmcnt(6)
  v_mfma_f32_32x32x16_bf16 v[32:47], v[72:75], a[24:27], v[32:47]
  ds_read_b64_tr_b16 v[60:61], v11 offset:38912
  ds_read_b64_tr_b16 v[62:63], v11 offset:39424
  v_mul_f32 v154, s62, v154
  v_exp_f32 v154, v154
  v_exp_f32 v82, v82
  v_add_f32 v154, 1.0, v154
  v_rcp_f32 v154, v154
  v_mfma_f32_32x32x16_bf16 v[32:47], v[76:79], a[28:31], v[32:47]
  s_branch Lts1
Ltp1:
  s_branch Ltp5
Lts1:
  ds_read_b64_tr_b16 v[64:65], v11 offset:40960
  ds_read_b64_tr_b16 v[66:67], v11 offset:41472
  s_add_u32 m0, s58, 48896
  v_readlane_b32 s7, v154, 31
  buffer_load_dwordx4 v6, s[32:35], s67 offen offset:256 lds
  buffer_load_dwordx4 v14, s[32:35], s67 offen offset:1280 lds
  s_waitcnt lgkmcnt(6)
  v_mfma_f32_32x32x16_bf16 v[32:47], v[48:51], a[32:35], v[32:47]
  ds_read_b64_tr_b16 v[68:69], v11 offset:43008
  ds_read_b64_tr_b16 v[70:71], v11 offset:43520
  v_readlane_b32 s81, v154, 63
  v_exp_f32 v83, v83
  v_add_f32 v80, 1.0, v80
  v_add_f32 v81, 1.0, v81
  v_add_f32 v82, 1.0, v82
  v_mfma_f32_32x32x16_bf16 v[32:47], v[52:55], a[36:39], v[32:47]
  ds_read_b64_tr_b16 v[72:73], v11 offset:45056
  ds_read_b64_tr_b16 v[74:75], v11 offset:45568
  v_add_f32 v83, 1.0, v83
  v_rcp_f32 v80, v80
  v_rcp_f32 v81, v81
  s_waitcnt lgkmcnt(6)
  v_mfma_f32_32x32x16_bf16 v[32:47], v[56:59], a[40:43], v[32:47]
  ds_read_b64_tr_b16 v[76:77], v11 offset:47104
  ds_read_b64_tr_b16 v[78:79], v11 offset:47616
  v_rcp_f32 v82, v82
  v_rcp_f32 v83, v83
  v_mul_f32 v80, v80, v16
  v_mul_f32 v81, v81, v17
  v_mfma_f32_32x32x16_bf16 v[32:47], v[60:63], a[44:47], v[32:47]
  s_waitcnt vmcnt(23)
  s_barrier
  ds_read_b64_tr_b16 v[48:49], v11 offset:49152
  ds_read_b64_tr_b16 v[50:51], v11 offset:49664
  s_add_u32 m0, s58, 57088
  v_mul_f32 v82, v82, v18
  buffer_load_dwordx4 v6, s[32:35], s68 offen offset:256 lds
  v_mul_f32 v83, v83, v19
  s_waitcnt lgkmcnt(6)
  v_mfma_f32_32x32x16_bf16 v[32:47], v[64:67], a[48:51], v[32:47]
  ds_read_b64_tr_b16 v[52:53], v11 offset:51200
  ds_read_b64_tr_b16 v[54:55], v11 offset:51712
  buffer_load_dwordx4 v14, s[32:35], s68 offen offset:1280 lds
  v_cvt_pk_bf16_f32 v96, v80, v81
  v_cvt_pk_bf16_f32 v97, v82, v83
  v_mul_f32 v84, s62, v20
  v_mul_f32 v85, s62, v21
  v_mfma_f32_32x32x16_bf16 v[32:47], v[68:71], a[52:55], v[32:47]
  ds_read_b64_tr_b16 v[56:57], v11 offset:53248
  ds_read_b64_tr_b16 v[58:59], v11 offset:53760
  v_mul_f32 v86, s62, v22
  v_mul_f32 v87, s62, v23
  v_exp_f32 v84, v84
  v_exp_f32 v85, v85
  s_waitcnt lgkmcnt(6)
  v_mfma_f32_32x32x16_bf16 v[32:47], v[72:75], a[56:59], v[32:47]
  ds_read_b64_tr_b16 v[60:61], v11 offset:55296
  ds_read_b64_tr_b16 v[62:63], v11 offset:55808
  v_exp_f32 v86, v86
  v_exp_f32 v87, v87
  v_add_f32 v84, 1.0, v84
  v_add_f32 v85, 1.0, v85
  v_mfma_f32_32x32x16_bf16 v[32:47], v[76:79], a[60:63], v[32:47]
  ds_read_b64_tr_b16 v[64:65], v11 offset:57344
  ds_read_b64_tr_b16 v[66:67], v11 offset:57856
  s_add_u32 m0, s58, 65280
  v_add_f32 v86, 1.0, v86
  buffer_load_dwordx4 v6, s[32:35], s69 offen offset:256 lds
  buffer_load_dwordx4 v14, s[32:35], s69 offen offset:1280 lds
  s_waitcnt lgkmcnt(6)
  v_mfma_f32_32x32x16_bf16 v[32:47], v[48:51], a[64:67], v[32:47]
  ds_read_b64_tr_b16 v[68:69], v11 offset:59392
  ds_read_b64_tr_b16 v[70:71], v11 offset:59904
  buffer_load_dword v104, v9, s[48:51], s38 offen sc1
  v_add_f32 v87, 1.0, v87
  v_rcp_f32 v84, v84
  v_rcp_f32 v85, v85
  v_mfma_f32_32x32x16_bf16 v[32:47], v[52:55], a[68:71], v[32:47]
  ds_read_b64_tr_b16 v[72:73], v11 offset:61440
  ds_read_b64_tr_b16 v[74:75], v11 offset:61952
  v_rcp_f32 v86, v86
  v_rcp_f32 v87, v87
  v_mul_f32 v84, v84, v20
  v_mul_f32 v85, v85, v21
  s_waitcnt lgkmcnt(6)
  v_mfma_f32_32x32x16_bf16 v[32:47], v[56:59], a[72:75], v[32:47]
  ds_read_b64_tr_b16 v[76:77], v11 offset:63488
  ds_read_b64_tr_b16 v[78:79], v11 offset:64000
  v_mul_f32 v86, v86, v22
  v_mul_f32 v87, v87, v23
  v_cvt_pk_bf16_f32 v98, v84, v85
  v_cvt_pk_bf16_f32 v99, v86, v87
  buffer_store_dwordx4 v[96:99], v13, s[48:51], s74 offen offset:0 sc1
  v_mul_f32 v80, s62, v24
  v_mfma_f32_32x32x16_bf16 v[32:47], v[60:63], a[76:79], v[32:47]
  s_waitcnt vmcnt(24)
  s_barrier
  ds_read_b64_tr_b16 v[48:49], v12 offset:0
  ds_read_b64_tr_b16 v[50:51], v12 offset:512
  s_add_u32 m0, s58, 73472
  v_mul_f32 v81, s62, v25
  buffer_load_dwordx4 v6, s[32:35], s70 offen offset:256 lds
  v_mul_f32 v82, s62, v26
  s_waitcnt lgkmcnt(6)
  v_mfma_f32_32x32x16_bf16 v[32:47], v[64:67], a[80:83], v[32:47]
  ds_read_b64_tr_b16 v[52:53], v12 offset:2048
  ds_read_b64_tr_b16 v[54:55], v12 offset:2560
  buffer_load_dwordx4 v14, s[32:35], s70 offen offset:1280 lds
  s_waitcnt vmcnt(16)
  ds_read_b64_tr_b16 v[114:115], v109 offset:0
  ds_read_b64_tr_b16 v[116:117], v109 offset:128
  ds_read_b64_tr_b16 v[118:119], v109 offset:256
  v_mfma_f32_32x32x16_bf16 v[32:47], v[68:71], a[84:87], v[32:47]
  ds_read_b64_tr_b16 v[56:57], v12 offset:4096
  ds_read_b64_tr_b16 v[58:59], v12 offset:4608
  ds_read_b64_tr_b16 v[120:121], v109 offset:384
  ds_read_b64_tr_b16 v[122:123], v109 offset:512
  ds_read_b64_tr_b16 v[124:125], v109 offset:640
  ds_read_b64_tr_b16 v[126:127], v109 offset:768
  ds_read_b64_tr_b16 v[128:129], v109 offset:896
  ds_read_b64_tr_b16 v[130:131], v109 offset:1024
  s_waitcnt lgkmcnt(15)
  v_mfma_f32_32x32x16_bf16 v[32:47], v[72:75], a[88:91], v[32:47]
  ds_read_b64_tr_b16 v[60:61], v12 offset:6144
  ds_read_b64_tr_b16 v[62:63], v12 offset:6656
  ds_read_b64_tr_b16 v[132:133], v109 offset:1152
  ds_read_b64_tr_b16 v[134:135], v109 offset:1280
  ds_read_b64_tr_b16 v[136:137], v109 offset:1408
  ds_read_b64_tr_b16 v[138:139], v109 offset:1536
  ds_read_b64_tr_b16 v[140:141], v109 offset:1664
  ds_read_b64_tr_b16 v[142:143], v109 offset:1792
  v_mfma_f32_32x32x16_bf16 v[32:47], v[76:79], a[92:95], v[32:47]
  ds_read_b64_tr_b16 v[64:65], v12 offset:8192
  ds_read_b64_tr_b16 v[66:67], v12 offset:8704
  s_add_u32 m0, s58, 81664
  ds_read_b64_tr_b16 v[144:145], v109 offset:1920
  buffer_load_dwordx4 v6, s[32:35], s71 offen offset:256 lds
  buffer_load_dwordx4 v14, s[32:35], s71 offen offset:1280 lds
  s_waitcnt lgkmcnt(15)
  v_mfma_f32_32x32x16_bf16 v[32:47], v[48:51], a[96:99], v[32:47]
  ds_read_b64_tr_b16 v[68:69], v12 offset:10240
  ds_read_b64_tr_b16 v[70:71], v12 offset:10752
  v_add_u32 v109, s54, v109
  ds_read_b64_tr_b16 v[146:147], v109 offset:2048
  ds_read_b64_tr_b16 v[148:149], v109 offset:2176
  ds_read_b64_tr_b16 v[150:151], v109 offset:2304
  ds_read_b64_tr_b16 v[152:153], v109 offset:2432
  ds_read_b64_tr_b16 v[154:155], v109 offset:2560
  v_mfma_f32_32x32x16_bf16 v[32:47], v[52:55], a[100:103], v[32:47]
  ds_read_b64_tr_b16 v[72:73], v12 offset:12288
  ds_read_b64_tr_b16 v[74:75], v12 offset:12800
  ds_read_b64_tr_b16 v[156:157], v109 offset:2688
  ds_read_b64_tr_b16 v[158:159], v109 offset:2816
  ds_read_b64_tr_b16 v[160:161], v109 offset:2944
  ds_read_b64_tr_b16 v[162:163], v109 offset:3072
  ds_read_b64_tr_b16 v[164:165], v109 offset:3200
  ds_read_b64_tr_b16 v[166:167], v109 offset:3328
  s_waitcnt lgkmcnt(15)
  v_mfma_f32_32x32x16_bf16 v[32:47], v[56:59], a[104:107], v[32:47]
  ds_read_b64_tr_b16 v[76:77], v12 offset:14336
  ds_read_b64_tr_b16 v[78:79], v12 offset:14848
  ds_read_b64_tr_b16 v[168:169], v109 offset:3456
  ds_read_b64_tr_b16 v[170:171], v109 offset:3584
  ds_read_b64_tr_b16 v[172:173], v109 offset:3712
  ds_read_b64_tr_b16 v[174:175], v109 offset:3840
  ds_read_b64_tr_b16 v[176:177], v109 offset:3968
  v_mov_b32 v15, s60
  v_mfma_f32_32x32x16_bf16 v[32:47], v[60:63], a[108:111], v[32:47]
  s_barrier
  ds_read_b64_tr_b16 v[48:49], v12 offset:16384
  ds_read_b64_tr_b16 v[50:51], v12 offset:16896
  s_add_u32 m0, s58, 89856
  v_writelane_b32 v15, s7, 1
  buffer_load_dwordx4 v6, s[32:35], s72 offen offset:256 lds
  buffer_load_dwordx4 v14, s[32:35], s72 offen offset:1280 lds
  s_waitcnt lgkmcnt(15)
  v_mfma_f32_32x32x16_bf16 v[32:47], v[64:67], a[112:115], v[32:47]
  ds_read_b64_tr_b16 v[52:53], v12 offset:18432
  ds_read_b64_tr_b16 v[54:55], v12 offset:18944
  v_writelane_b32 v15, s81, 3
  v_mov_b32 v109, 0
  v_mul_f32 v83, s62, v27
  v_exp_f32 v80, v80
  v_mfma_f32_32x32x16_bf16 v[32:47], v[68:71], a[116:119], v[32:47]
  ds_read_b64_tr_b16 v[56:57], v12 offset:20480
  ds_read_b64_tr_b16 v[58:59], v12 offset:20992
  v_exp_f32 v81, v81
  v_exp_f32 v82, v82
  v_exp_f32 v83, v83
  s_waitcnt lgkmcnt(11)
  v_mfma_f32_32x32x16_bf16 v[32:47], v[72:75], a[120:123], v[32:47]
  ds_read_b64_tr_b16 v[60:61], v12 offset:22528
  ds_read_b64_tr_b16 v[62:63], v12 offset:23040
  s_waitcnt vmcnt(7)
  v_cmp_ne_u32 vcc, s59, v104
  s_cbranch_vccz Lgot_4
Lpoll_3:
  s_sleep 1
  buffer_load_dword v104, v9, s[48:51], s38 offen sc1
  s_waitcnt vmcnt(0)
  s_sub_u32 s79, s79, 1
  s_cbranch_scc1 Lend
  v_cmp_ne_u32 vcc, s59, v104
  s_cbranch_vccnz Lpoll_3
Lgot_4:
  buffer_store_dword v107, v7, s[48:51], s39 offen sc1
  s_waitcnt lgkmcnt(8)
  s_mov_b32 m0, s36
  v_mfma_f32_32x32x16_bf16 v[32:47], v[76:79], a[124:127], v[32:47]
  ds_read_b64_tr_b16 v[64:65], v12 offset:24576
  ds_read_b64_tr_b16 v[66:67], v12 offset:25088
  buffer_load_dwordx4 v2, s[48:51], s61 offen offset:0 sc1 lds
  buffer_load_dwordx4 v2, s[48:51], s61 offen offset:1024 sc1 lds
  s_lshl4_add_u32 s61, s54, s61
  s_add_u32 s61, s61, s54
  s_add_u32 m0, s36, s54
  s_waitcnt lgkmcnt(6)
  v_mfma_f32_32x32x16_bf16 v[32:47], v[48:51], a[128:131], v[32:47]
  ds_read_b64_tr_b16 v[68:69], v12 offset:26624
  ds_read_b64_tr_b16 v[70:71], v12 offset:27136
  buffer_load_dwordx4 v2, s[48:51], s61 offen offset:2048 sc1 lds
  buffer_load_dwordx4 v2, s[48:51], s61 offen offset:3072 sc1 lds
  s_add_u32 s61, s61, 3145728
  s_add_u32 m0, s58, 98048
  v_mfma_f32_32x32x16_bf16 v[32:47], v[52:55], a[132:135], v[32:47]
  ds_read_b64_tr_b16 v[72:73], v12 offset:28672
  ds_read_b64_tr_b16 v[74:75], v12 offset:29184
  buffer_load_dwordx4 v6, s[32:35], s73 offen offset:256 lds
  buffer_load_dwordx4 v14, s[32:35], s73 offen offset:1280 lds
  buffer_load_dwordx4 a[160:163], v2, s[48:51], s37 offen offset:0 sc1
  s_waitcnt lgkmcnt(6)
  v_mfma_f32_32x32x16_bf16 v[32:47], v[56:59], a[136:139], v[32:47]
  ds_read_b64_tr_b16 v[76:77], v12 offset:30720
  ds_read_b64_tr_b16 v[78:79], v12 offset:31232
  buffer_load_dwordx4 a[164:167], v2, s[48:51], s37 offen offset:1024 sc1
  v_add_f32 v80, 1.0, v80
  v_add_f32 v81, 1.0, v81
  v_add_f32 v82, 1.0, v82
  v_add_f32 v83, 1.0, v83
  v_mfma_f32_32x32x16_bf16 v[32:47], v[60:63], a[140:143], v[32:47]
  s_barrier
  ds_read_b64_tr_b16 v[48:49], v10 offset:24576
  ds_read_b64_tr_b16 v[50:51], v10 offset:25088
  v_rcp_f32 v80, v80
  v_rcp_f32 v81, v81
  v_rcp_f32 v82, v82
  s_waitcnt lgkmcnt(6)
  v_mfma_f32_32x32x16_bf16 v[32:47], v[64:67], a[144:147], v[32:47]
  ds_read_b64_tr_b16 v[52:53], v10 offset:26624
  ds_read_b64_tr_b16 v[54:55], v10 offset:27136
  buffer_load_dwordx4 a[168:171], v2, s[48:51], s37 offen offset:2048 sc1
  v_rcp_f32 v83, v83
  v_mul_f32 v80, v80, v24
  v_mul_f32 v81, v81, v25
  v_mfma_f32_32x32x16_bf16 v[32:47], v[68:71], a[148:151], v[32:47]
  ds_read_b64_tr_b16 v[56:57], v10 offset:28672
  ds_read_b64_tr_b16 v[58:59], v10 offset:29184
  v_mul_f32 v82, v82, v26
  v_mul_f32 v83, v83, v27
  v_cvt_pk_bf16_f32 v100, v80, v81
  v_cvt_pk_bf16_f32 v101, v82, v83
  v_mul_f32 v84, s62, v28
  v_mul_f32 v85, s62, v29
  s_waitcnt lgkmcnt(6)
  v_mfma_f32_32x32x16_bf16 v[32:47], v[72:75], a[152:155], v[32:47]
  ds_read_b64_tr_b16 v[60:61], v10 offset:30720
  ds_read_b64_tr_b16 v[62:63], v10 offset:31232
  buffer_load_dwordx4 a[172:175], v2, s[48:51], s37 offen offset:3072 sc1
  v_mul_f32 v86, s62, v30
  v_mul_f32 v87, s62, v31
  v_exp_f32 v84, v84
  v_mfma_f32_32x32x16_bf16 v[32:47], v[76:79], a[156:159], v[32:47]
  ds_read_b64_tr_b16 v[64:65], v10 offset:32768
  ds_read_b64_tr_b16 v[66:67], v10 offset:33280
  v_exp_f32 v85, v85
  v_exp_f32 v86, v86
  v_exp_f32 v87, v87
  v_add_f32 v84, 1.0, v84
  v_add_f32 v85, 1.0, v85
  v_add_f32 v86, 1.0, v86
  v_add_f32 v87, 1.0, v87
  v_rcp_f32 v84, v84
  v_rcp_f32 v85, v85
  v_rcp_f32 v86, v86
  v_rcp_f32 v87, v87
  v_mul_f32 v84, v84, v28
  v_mul_f32 v85, v85, v29
  v_mul_f32 v86, v86, v30
  v_mul_f32 v87, v87, v31
  v_cvt_pk_bf16_f32 v102, v84, v85
  v_cvt_pk_bf16_f32 v103, v86, v87
  buffer_store_dwordx4 v[100:103], v13, s[48:51], s74 offen offset:512 sc1
  s_waitcnt lgkmcnt(6)
  v_mfma_f32_32x32x16_bf16 v[16:31], v[48:51], a[0:3], 0
  ds_read_b64_tr_b16 v[68:69], v10 offset:34816
  ds_read_b64_tr_b16 v[70:71], v10 offset:35328
  v_mfma_f32_32x32x16_bf16 v[16:31], v[52:55], a[4:7], v[16:31]
  ds_read_b64_tr_b16 v[72:73], v10 offset:36864
  ds_read_b64_tr_b16 v[74:75], v10 offset:37376
  s_add_u32 s37, s37, 4096
  buffer_load_dwordx4 a[176:179], v2, s[48:51], s37 offen offset:0 sc1
  s_waitcnt lgkmcnt(6)
  v_mfma_f32_32x32x16_bf16 v[16:31], v[56:59], a[8:11], v[16:31]
  ds_read_b64_tr_b16 v[76:77], v10 offset:38912
  ds_read_b64_tr_b16 v[78:79], v10 offset:39424
  buffer_load_dwordx4 a[180:183], v2, s[48:51], s37 offen offset:1024 sc1
  v_mul_f32 v80, s62, v32
  v_mul_f32 v81, s62, v33
  v_mul_f32 v82, s62, v34
  v_mul_f32 v83, s62, v35
  v_mfma_f32_32x32x16_bf16 v[16:31], v[60:63], a[12:15], v[16:31]
  s_barrier
  ds_read_b64_tr_b16 v[48:49], v10 offset:40960
  ds_read_b64_tr_b16 v[50:51], v10 offset:41472
  v_exp_f32 v80, v80
  v_exp_f32 v81, v81
  v_exp_f32 v82, v82
  s_waitcnt lgkmcnt(6)
  v_mfma_f32_32x32x16_bf16 v[16:31], v[64:67], a[16:19], v[16:31]
  ds_read_b64_tr_b16 v[52:53], v10 offset:43008
  ds_read_b64_tr_b16 v[54:55], v10 offset:43520
  buffer_load_dwordx4 a[184:187], v2, s[48:51], s37 offen offset:2048 sc1
  v_exp_f32 v83, v83
  v_add_f32 v80, 1.0, v80
  v_add_f32 v81, 1.0, v81
  v_mfma_f32_32x32x16_bf16 v[16:31], v[68:71], a[20:23], v[16:31]
  ds_read_b64_tr_b16 v[56:57], v10 offset:45056
  ds_read_b64_tr_b16 v[58:59], v10 offset:45568
  v_add_f32 v82, 1.0, v82
  v_add_f32 v83, 1.0, v83
  v_rcp_f32 v80, v80
  v_rcp_f32 v81, v81
  s_waitcnt lgkmcnt(6)
  v_mfma_f32_32x32x16_bf16 v[16:31], v[72:75], a[24:27], v[16:31]
  ds_read_b64_tr_b16 v[60:61], v10 offset:47104
  ds_read_b64_tr_b16 v[62:63], v10 offset:47616
  buffer_load_dwordx4 a[188:191], v2, s[48:51], s37 offen offset:3072 sc1
  v_rcp_f32 v82, v82
  v_rcp_f32 v83, v83
  v_mfma_f32_32x32x16_bf16 v[16:31], v[76:79], a[28:31], v[16:31]
  ds_read_b64_tr_b16 v[64:65], v10 offset:49152
  ds_read_b64_tr_b16 v[66:67], v10 offset:49664
  v_mul_f32 v80, v80, v32
  v_mul_f32 v81, v81, v33
  v_mul_f32 v82, v82, v34
  v_mul_f32 v83, v83, v35
  v_cvt_pk_bf16_f32 v96, v80, v81
  v_cvt_pk_bf16_f32 v97, v82, v83
  s_waitcnt lgkmcnt(6)
  v_mfma_f32_32x32x16_bf16 v[16:31], v[48:51], a[32:35], v[16:31]
  ds_read_b64_tr_b16 v[68:69], v10 offset:51200
  ds_read_b64_tr_b16 v[70:71], v10 offset:51712
  s_add_u32 s37, s37, 4096
  buffer_load_dwordx4 a[192:195], v2, s[48:51], s37 offen offset:0 sc1
  v_mul_f32 v84, s62, v36
  v_mul_f32 v85, s62, v37
  v_mul_f32 v86, s62, v38
  v_mfma_f32_32x32x16_bf16 v[16:31], v[52:55], a[36:39], v[16:31]
  ds_read_b64_tr_b16 v[72:73], v10 offset:53248
  ds_read_b64_tr_b16 v[74:75], v10 offset:53760
  v_mul_f32 v87, s62, v39
  v_exp_f32 v84, v84
  v_exp_f32 v85, v85
  s_waitcnt lgkmcnt(6)
  v_mfma_f32_32x32x16_bf16 v[16:31], v[56:59], a[40:43], v[16:31]
  ds_read_b64_tr_b16 v[76:77], v10 offset:55296
  ds_read_b64_tr_b16 v[78:79], v10 offset:55808
  buffer_load_dwordx4 a[196:199], v2, s[48:51], s37 offen offset:1024 sc1
  v_exp_f32 v86, v86
  v_exp_f32 v87, v87
  v_mfma_f32_32x32x16_bf16 v[16:31], v[60:63], a[44:47], v[16:31]
  s_barrier
  ds_read_b64_tr_b16 v[48:49], v10 offset:57344
  ds_read_b64_tr_b16 v[50:51], v10 offset:57856
  v_add_f32 v84, 1.0, v84
  v_add_f32 v85, 1.0, v85
  v_add_f32 v86, 1.0, v86
  v_add_f32 v87, 1.0, v87
  v_rcp_f32 v84, v84
  s_waitcnt lgkmcnt(6)
  v_mfma_f32_32x32x16_bf16 v[16:31], v[64:67], a[48:51], v[16:31]
  ds_read_b64_tr_b16 v[52:53], v10 offset:59392
  ds_read_b64_tr_b16 v[54:55], v10 offset:59904
  buffer_load_dwordx4 a[200:203], v2, s[48:51], s37 offen offset:2048 sc1
  v_rcp_f32 v85, v85
  v_rcp_f32 v86, v86
  v_mfma_f32_32x32x16_bf16 v[16:31], v[68:71], a[52:55], v[16:31]
  ds_read_b64_tr_b16 v[56:57], v10 offset:61440
  ds_read_b64_tr_b16 v[58:59], v10 offset:61952
  v_rcp_f32 v87, v87
  v_mul_f32 v84, v84, v36
  v_mul_f32 v85, v85, v37
  v_mul_f32 v86, v86, v38
  v_mul_f32 v87, v87, v39
  s_waitcnt lgkmcnt(6)
  v_mfma_f32_32x32x16_bf16 v[16:31], v[72:75], a[56:59], v[16:31]
  ds_read_b64_tr_b16 v[60:61], v10 offset:63488
  ds_read_b64_tr_b16 v[62:63], v10 offset:64000
  buffer_load_dwordx4 a[204:207], v2, s[48:51], s37 offen offset:3072 sc1
  v_cvt_pk_bf16_f32 v98, v84, v85
  v_cvt_pk_bf16_f32 v99, v86, v87
  buffer_store_dwordx4 v[96:99], v13, s[48:51], s75 offen offset:0 sc1
  v_mul_f32 v80, s62, v40
  v_mfma_f32_32x32x16_bf16 v[16:31], v[76:79], a[60:63], v[16:31]
  ds_read_b64_tr_b16 v[64:65], v11 offset:0
  ds_read_b64_tr_b16 v[66:67], v11 offset:512
  v_mul_f32 v81, s62, v41
  v_mul_f32 v82, s62, v42
  v_mul_f32 v83, s62, v43
  v_exp_f32 v80, v80
  s_waitcnt lgkmcnt(6)
  v_mfma_f32_32x32x16_bf16 v[16:31], v[48:51], a[64:67], v[16:31]
  ds_read_b64_tr_b16 v[68:69], v11 offset:2048
  ds_read_b64_tr_b16 v[70:71], v11 offset:2560
  s_add_u32 s37, s37, 4096
  buffer_load_dwordx4 a[208:211], v2, s[48:51], s37 offen offset:0 sc1
  v_exp_f32 v81, v81
  v_mfma_f32_32x32x16_bf16 v[16:31], v[52:55], a[68:71], v[16:31]
  ds_read_b64_tr_b16 v[72:73], v11 offset:4096
  ds_read_b64_tr_b16 v[74:75], v11 offset:4608
  v_exp_f32 v82, v82
  v_exp_f32 v83, v83
  v_add_f32 v80, 1.0, v80
  v_add_f32 v81, 1.0, v81
  s_waitcnt lgkmcnt(6)
  v_mfma_f32_32x32x16_bf16 v[16:31], v[56:59], a[72:75], v[16:31]
  ds_read_b64_tr_b16 v[76:77], v11 offset:6144
  ds_read_b64_tr_b16 v[78:79], v11 offset:6656
  buffer_load_dwordx4 a[212:215], v2, s[48:51], s37 offen offset:1024 sc1
  v_add_f32 v82, 1.0, v82
  v_add_f32 v83, 1.0, v83
  v_rcp_f32 v80, v80
  v_mfma_f32_32x32x16_bf16 v[16:31], v[60:63], a[76:79], v[16:31]
  s_waitcnt vmcnt(25)
  s_barrier
  ds_read_b64_tr_b16 v[48:49], v11 offset:8192
  ds_read_b64_tr_b16 v[50:51], v11 offset:8704
  v_rcp_f32 v81, v81
  v_rcp_f32 v82, v82
  s_waitcnt lgkmcnt(6)
  v_mfma_f32_32x32x16_bf16 v[16:31], v[64:67], a[80:83], v[16:31]
  ds_read_b64_tr_b16 v[52:53], v11 offset:10240
  ds_read_b64_tr_b16 v[54:55], v11 offset:10752
  buffer_load_dwordx4 a[216:219], v2, s[48:51], s37 offen offset:2048 sc1
  v_rcp_f32 v83, v83
  v_mul_f32 v80, v80, v40
  v_mul_f32 v81, v81, v41
  v_mfma_f32_32x32x16_bf16 v[16:31], v[68:71], a[84:87], v[16:31]
  ds_read_b64_tr_b16 v[56:57], v11 offset:12288
  ds_read_b64_tr_b16 v[58:59], v11 offset:12800
  v_mul_f32 v82, v82, v42
  v_mul_f32 v83, v83, v43
  v_cvt_pk_bf16_f32 v100, v80, v81
  v_cvt_pk_bf16_f32 v101, v82, v83
  v_mul_f32 v84, s62, v44
  v_mul_f32 v85, s62, v45
  s_waitcnt lgkmcnt(6)
  v_mfma_f32_32x32x16_bf16 v[16:31], v[72:75], a[88:91], v[16:31]
  ds_read_b64_tr_b16 v[60:61], v11 offset:14336
  ds_read_b64_tr_b16 v[62:63], v11 offset:14848
  buffer_load_dwordx4 a[220:223], v2, s[48:51], s37 offen offset:3072 sc1
  v_mul_f32 v86, s62, v46
  v_mul_f32 v87, s62, v47
  v_exp_f32 v84, v84
  v_mfma_f32_32x32x16_bf16 v[16:31], v[76:79], a[92:95], v[16:31]
  ds_read_b64_tr_b16 v[64:65], v11 offset:16384
  ds_read_b64_tr_b16 v[66:67], v11 offset:16896
  v_exp_f32 v85, v85
  v_exp_f32 v86, v86
  v_exp_f32 v87, v87
  s_waitcnt lgkmcnt(6)
  v_mfma_f32_32x32x16_bf16 v[16:31], v[48:51], a[96:99], v[16:31]
  ds_read_b64_tr_b16 v[68:69], v11 offset:18432
  ds_read_b64_tr_b16 v[70:71], v11 offset:18944
  s_add_u32 s37, s37, 4096
  buffer_load_dwordx4 a[224:227], v2, s[48:51], s37 offen offset:0 sc1
  s_waitcnt vmcnt(21)
  ds_read_b64_tr_b16 v[178:179], v110 offset:3968
  ds_read_b64_tr_b16 v[180:181], v110 offset:3840
  v_mfma_f32_32x32x16_bf16 v[16:31], v[52:55], a[100:103], v[16:31]
  ds_read_b64_tr_b16 v[72:73], v11 offset:20480
  ds_read_b64_tr_b16 v[74:75], v11 offset:20992
  ds_read_b64_tr_b16 v[182:183], v110 offset:3712
  ds_read_b64_tr_b16 v[184:185], v110 offset:3584
  ds_read_b64_tr_b16 v[186:187], v110 offset:3456
  ds_read_b64_tr_b16 v[188:189], v110 offset:3328
  ds_read_b64_tr_b16 v[190:191], v110 offset:3200
  ds_read_b64_tr_b16 v[192:193], v110 offset:3072
  s_waitcnt lgkmcnt(14)
  v_mfma_f32_32x32x16_bf16 v[16:31], v[56:59], a[104:107], v[16:31]
  ds_read_b64_tr_b16 v[76:77], v11 offset:22528
  ds_read_b64_tr_b16 v[78:79], v11 offset:23040
  buffer_load_dwordx4 a[228:231], v2, s[48:51], s37 offen offset:1024 sc1
  ds_read_b64_tr_b16 v[194:195], v110 offset:2944
  ds_read_b64_tr_b16 v[196:197], v110 offset:2816
  ds_read_b64_tr_b16 v[198:199], v110 offset:2688
  ds_read_b64_tr_b16 v[200:201], v110 offset:2560
  v_mfma_f32_32x32x16_bf16 v[16:31], v[60:63], a[108:111], v[16:31]
  s_waitcnt vmcnt(20)
  s_barrier
  ds_read_b64_tr_b16 v[48:49], v11 offset:24576
  ds_read_b64_tr_b16 v[50:51], v11 offset:25088
  ds_read_b64_tr_b16 v[202:203], v110 offset:2432
  ds_read_b64_tr_b16 v[204:205], v110 offset:2304
  ds_read_b64_tr_b16 v[206:207], v110 offset:2176
  ds_read_b64_tr_b16 v[208:209], v110 offset:2048
  v_subrev_u32 v110, s54, v110
  s_waitcnt lgkmcnt(15)
  v_mfma_f32_32x32x16_bf16 v[16:31], v[64:67], a[112:115], v[16:31]
  ds_read_b64_tr_b16 v[52:53], v11 offset:26624
  ds_read_b64_tr_b16 v[54:55], v11 offset:27136
  buffer_load_dwordx4 a[232:235], v2, s[48:51], s37 offen offset:2048 sc1
  ds_read_b64_tr_b16 v[210:211], v110 offset:1920
  ds_read_b64_tr_b16 v[212:213], v110 offset:1792
  ds_read_b64_tr_b16 v[214:215], v110 offset:1664
  ds_read_b64_tr_b16 v[216:217], v110 offset:1536
  v_mfma_f32_32x32x16_bf16 v[16:31], v[68:71], a[116:119], v[16:31]
  ds_read_b64_tr_b16 v[56:57], v11 offset:28672
  ds_read_b64_tr_b16 v[58:59], v11 offset:29184
  ds_read_b64_tr_b16 v[218:219], v110 offset:1408
  ds_read_b64_tr_b16 v[220:221], v110 offset:1280
  ds_read_b64_tr_b16 v[222:223], v110 offset:1152
  ds_read_b64_tr_b16 v[224:225], v110 offset:1024
  ds_read_b64_tr_b16 v[226:227], v110 offset:896
  ds_read_b64_tr_b16 v[228:229], v110 offset:768
  s_waitcnt lgkmcnt(15)
  v_mfma_f32_32x32x16_bf16 v[16:31], v[72:75], a[120:123], v[16:31]
  ds_read_b64_tr_b16 v[60:61], v11 offset:30720
  ds_read_b64_tr_b16 v[62:63], v11 offset:31232
  buffer_load_dwordx4 a[236:239], v2, s[48:51], s37 offen offset:3072 sc1
  ds_read_b64_tr_b16 v[230:231], v110 offset:640
  ds_read_b64_tr_b16 v[232:233], v110 offset:512
  ds_read_b64_tr_b16 v[234:235], v110 offset:384
  ds_read_b64_tr_b16 v[236:237], v110 offset:256
  v_mfma_f32_32x32x16_bf16 v[16:31], v[76:79], a[124:127], v[16:31]
  ds_read_b64_tr_b16 v[64:65], v11 offset:32768
  ds_read_b64_tr_b16 v[66:67], v11 offset:33280
  ds_read_b64_tr_b16 v[238:239], v110 offset:128
  ds_read_b64_tr_b16 v[240:241], v110 offset:0
  v_add_f32 v84, 1.0, v84
  v_add_f32 v85, 1.0, v85
  v_add_f32 v86, 1.0, v86
  v_add_f32 v87, 1.0, v87
  s_waitcnt lgkmcnt(15)
  v_mfma_f32_32x32x16_bf16 v[16:31], v[48:51], a[128:131], v[16:31]
  ds_read_b64_tr_b16 v[68:69], v11 offset:34816
  ds_read_b64_tr_b16 v[70:71], v11 offset:35328
  s_add_u32 s37, s37, 4096
  buffer_load_dwordx4 a[0:3], v2, s[48:51], s37 offen offset:0 sc1
  v_rcp_f32 v84, v84
  v_mfma_f32_32x32x16_bf16 v[16:31], v[52:55], a[132:135], v[16:31]
  ds_read_b64_tr_b16 v[72:73], v11 offset:36864
  ds_read_b64_tr_b16 v[74:75], v11 offset:37376
  v_rcp_f32 v85, v85
  v_rcp_f32 v86, v86
  v_rcp_f32 v87, v87
  s_waitcnt lgkmcnt(12)
  v_mfma_f32_32x32x16_bf16 v[16:31], v[56:59], a[136:139], v[16:31]
  ds_read_b64_tr_b16 v[76:77], v11 offset:38912
  ds_read_b64_tr_b16 v[78:79], v11 offset:39424
  buffer_load_dwordx4 a[4:7], v2, s[48:51], s37 offen offset:1024 sc1
  v_mul_f32 v84, v84, v44
  v_mul_f32 v85, v85, v45
  v_mul_f32 v86, v86, v46
  v_mul_f32 v87, v87, v47
  v_mfma_f32_32x32x16_bf16 v[16:31], v[60:63], a[140:143], v[16:31]
  v_cvt_pk_bf16_f32 v102, v84, v85
  v_cvt_pk_bf16_f32 v103, v86, v87
  buffer_store_dwordx4 v[100:103], v13, s[48:51], s75 offen offset:512 sc1
  s_waitcnt lgkmcnt(4)
  v_mfma_f32_32x32x16_bf16 v[16:31], v[64:67], a[144:147], v[16:31]
  v_mfma_f32_32x32x16_bf16 v[16:31], v[68:71], a[148:151], v[16:31]
  s_waitcnt lgkmcnt(0)
  v_mfma_f32_32x32x16_bf16 v[16:31], v[72:75], a[152:155], v[16:31]
  v_mfma_f32_32x32x16_bf16 v[16:31], v[76:79], a[156:159], v[16:31]
  s_cmp_eq_u32 s54, 0
  s_nop 7
  s_nop 2
  s_cbranch_scc0 Lnoconv
  v_mov_b32 v0, v7
  v_mfma_f32_16x16x32_bf16 v[32:35], v[114:117], v[178:181], 0
  v_mul_f32 v80, s62, v16
  v_mul_f32 v81, s62, v17
  v_mul_f32 v82, s62, v18
  v_mul_f32 v83, s62, v19
  v_exp_f32 v80, v80
  v_exp_f32 v81, v81
  v_exp_f32 v82, v82
  v_exp_f32 v83, v83
  v_mfma_f32_16x16x32_bf16 v[32:35], v[118:121], v[182:185], v[32:35]
  v_add_f32 v80, 1.0, v80
  v_add_f32 v81, 1.0, v81
  v_add_f32 v82, 1.0, v82
  v_add_f32 v83, 1.0, v83
  v_rcp_f32 v80, v80
  v_rcp_f32 v81, v81
  v_rcp_f32 v82, v82
  v_rcp_f32 v83, v83
  v_mfma_f32_16x16x32_bf16 v[32:35], v[122:125], v[186:189], v[32:35]
  buffer_load_dwordx4 a[8:11], v2, s[48:51], s37 offen offset:2048 sc1
  v_mul_f32 v80, v80, v16
  v_mul_f32 v81, v81, v17
  v_mul_f32 v82, v82, v18
  v_mul_f32 v83, v83, v19
  v_cvt_pk_bf16_f32 v96, v80, v81
  v_cvt_pk_bf16_f32 v97, v82, v83
  v_mul_f32 v84, s62, v20
  v_mul_f32 v85, s62, v21
  v_mul_f32 v86, s62, v22
  v_mul_f32 v87, s62, v23
  ds_read_u16_d16_hi v252, v111 offset:3968
  v_mfma_f32_16x16x32_bf16 v[32:35], v[126:129], v[190:193], v[32:35]
  v_exp_f32 v84, v84
  v_exp_f32 v85, v85
  v_exp_f32 v86, v86
  v_exp_f32 v87, v87
  v_add_f32 v84, 1.0, v84
  v_add_f32 v85, 1.0, v85
  v_add_f32 v86, 1.0, v86
  v_add_f32 v87, 1.0, v87
  v_mfma_f32_16x16x32_bf16 v[32:35], v[130:133], v[194:197], v[32:35]
  v_rcp_f32 v84, v84
  v_rcp_f32 v85, v85
  v_rcp_f32 v86, v86
  v_rcp_f32 v87, v87
  v_mul_f32 v84, v84, v20
  v_mul_f32 v85, v85, v21
  v_mul_f32 v86, v86, v22
  v_mul_f32 v87, v87, v23
  v_mfma_f32_16x16x32_bf16 v[32:35], v[134:137], v[198:201], v[32:35]
  v_cvt_pk_bf16_f32 v98, v84, v85
  v_cvt_pk_bf16_f32 v99, v86, v87
  buffer_store_dwordx4 v[96:99], v13, s[48:51], s76 offen offset:0 sc1
  v_mul_f32 v80, s62, v24
  v_mul_f32 v81, s62, v25
  v_mul_f32 v82, s62, v26
  v_mul_f32 v83, s62, v27
  v_exp_f32 v80, v80
  v_exp_f32 v81, v81
  ds_read_u16_d16_hi v253, v111 offset:3840
  v_mfma_f32_16x16x32_bf16 v[32:35], v[138:141], v[202:205], v[32:35]
  v_exp_f32 v82, v82
  v_exp_f32 v83, v83
  v_add_f32 v80, 1.0, v80
  v_add_f32 v81, 1.0, v81
  v_add_f32 v82, 1.0, v82
  v_add_f32 v83, 1.0, v83
  v_rcp_f32 v80, v80
  v_rcp_f32 v81, v81
  v_mfma_f32_16x16x32_bf16 v[32:35], v[142:145], v[206:209], v[32:35]
  buffer_load_dwordx4 a[12:15], v2, s[48:51], s37 offen offset:3072 sc1
  v_rcp_f32 v82, v82
  v_rcp_f32 v83, v83
  v_mul_f32 v80, v80, v24
  v_mul_f32 v81, v81, v25
  s_branch Lts2
Ltp2:
  s_branch Ltp6
Lts2:
  v_mul_f32 v82, v82, v26
  v_mul_f32 v83, v83, v27
  v_cvt_pk_bf16_f32 v100, v80, v81
  v_cvt_pk_bf16_f32 v101, v82, v83
  v_mul_f32 v84, s62, v28
  v_mfma_f32_16x16x32_bf16 v[32:35], v[146:149], v[210:213], v[32:35]
  v_mul_f32 v85, s62, v29
  v_mul_f32 v86, s62, v30
  v_mul_f32 v87, s62, v31
  v_exp_f32 v84, v84
  v_exp_f32 v85, v85
  v_exp_f32 v86, v86
  v_exp_f32 v87, v87
  v_add_f32 v84, 1.0, v84
  v_mfma_f32_16x16x32_bf16 v[32:35], v[150:153], v[214:217], v[32:35]
  v_add_f32 v85, 1.0, v85
  v_add_f32 v86, 1.0, v86
  v_add_f32 v87, 1.0, v87
  v_rcp_f32 v84, v84
  v_rcp_f32 v85, v85
  v_rcp_f32 v86, v86
  v_rcp_f32 v87, v87
  v_mul_f32 v84, v84, v28
  v_mfma_f32_16x16x32_bf16 v[32:35], v[154:157], v[218:221], v[32:35]
  v_mul_f32 v85, v85, v29
  v_mul_f32 v86, v86, v30
  v_mul_f32 v87, v87, v31
  v_cvt_pk_bf16_f32 v102, v84, v85
  v_cvt_pk_bf16_f32 v103, v86, v87
  buffer_store_dwordx4 v[100:103], v13, s[48:51], s76 offen offset:512 sc1
  ds_read_u16_d16_hi v254, v111 offset:3712
  ds_read_u16_d16_hi v109, v111 offset:3584
  v_mfma_f32_16x16x32_bf16 v[32:35], v[158:161], v[222:225], v[32:35]
  v_mfma_f32_16x16x32_bf16 v[32:35], v[162:165], v[226:229], v[32:35]
  s_add_u32 s37, s37, 4096
  buffer_load_dwordx4 a[16:19], v2, s[48:51], s37 offen offset:0 sc1
  v_mfma_f32_16x16x32_bf16 v[32:35], v[166:169], v[230:233], v[32:35]
  v_mfma_f32_16x16x32_bf16 v[32:35], v[170:173], v[234:237], v[32:35]
  v_mfma_f32_16x16x32_bf16 v[32:35], v[174:177], v[238:241], v[32:35]
  v_mfma_f32_16x16x32_bf16 v[36:39], v[114:117], v[180:183], 0
  v_mfma_f32_16x16x32_bf16 v[36:39], v[118:121], v[184:187], v[36:39]
  buffer_load_dwordx4 a[20:23], v2, s[48:51], s37 offen offset:1024 sc1
  v_mfma_f32_16x16x32_bf16 v[36:39], v[122:125], v[188:191], v[36:39]
  v_mfma_f32_16x16x32_bf16 v[36:39], v[126:129], v[192:195], v[36:39]
  v_mfma_f32_16x16x32_bf16 v[36:39], v[130:133], v[196:199], v[36:39]
  v_mfma_f32_16x16x32_bf16 v[36:39], v[134:137], v[200:203], v[36:39]
  v_mfma_f32_16x16x32_bf16 v[36:39], v[138:141], v[204:207], v[36:39]
  buffer_load_dwordx4 a[24:27], v2, s[48:51], s37 offen offset:2048 sc1
  s_waitcnt lgkmcnt(3)
  v_fma_f32 v245, v252, v108, v32
  v_mfma_f32_16x16x32_bf16 v[36:39], v[142:145], v[208:211], v[36:39]
  v_mfma_f32_16x16x32_bf16 v[36:39], v[146:149], v[212:215], v[36:39]
  v_add_f32_dpp v247, v245, v33 wave_shl:1 row_mask:0xf bank_mask:0xf
  v_mfma_f32_16x16x32_bf16 v[36:39], v[150:153], v[216:219], v[36:39]
  v_mfma_f32_16x16x32_bf16 v[36:39], v[154:157], v[220:223], v[36:39]
  v_add_f32_dpp v249, v247, v34 wave_shl:1 row_mask:0xf bank_mask:0xf
  v_mfma_f32_16x16x32_bf16 v[36:39], v[158:161], v[224:227], v[36:39]
  buffer_load_dwordx4 a[28:31], v2, s[48:51], s37 offen offset:3072 sc1
  v_add_f32_dpp v250, v249, v35 wave_shl:1 row_mask:0xf bank_mask:0xf
  v_mfma_f32_16x16x32_bf16 v[36:39], v[162:165], v[228:231], v[36:39]
  v_mfma_f32_16x16x32_bf16 v[36:39], v[166:169], v[232:235], v[36:39]
  v_mfma_f32_16x16x32_bf16 v[36:39], v[170:173], v[236:239], v[36:39]
  v_mfma_f32_16x16x32_bf16 v[36:39], v[174:177], v[240:243], v[36:39]
  v_mfma_f32_16x16x32_bf16 v[40:43], v[114:117], v[182:185], 0
  s_add_u32 s37, s37, 4096
  buffer_load_dwordx4 a[32:35], v2, s[48:51], s37 offen offset:0 sc1
  v_mfma_f32_16x16x32_bf16 v[40:43], v[118:121], v[186:189], v[40:43]
  v_mfma_f32_16x16x32_bf16 v[40:43], v[122:125], v[190:193], v[40:43]
  v_mfma_f32_16x16x32_bf16 v[40:43], v[126:129], v[194:197], v[40:43]
  v_mfma_f32_16x16x32_bf16 v[40:43], v[130:133], v[198:201], v[40:43]
  v_mfma_f32_16x16x32_bf16 v[40:43], v[134:137], v[202:205], v[40:43]
  buffer_load_dwordx4 a[36:39], v2, s[48:51], s37 offen offset:1024 sc1
  v_add_f32_dpp v246, v245, v37 wave_rol:1 row_mask:0xf bank_mask:0xf
  v_mfma_f32_16x16x32_bf16 v[40:43], v[138:141], v[206:209], v[40:43]
  s_waitcnt lgkmcnt(2)
  v_fma_f32 v244, v253, v108, v36
  v_mfma_f32_16x16x32_bf16 v[40:43], v[142:145], v[210:213], v[40:43]
  v_add_f32_dpp v248, v247, v38 wave_rol:1 row_mask:0xf bank_mask:0xf
  v_add_f32_dpp v251, v249, v39 wave_rol:1 row_mask:0xf bank_mask:0xf
  v_mfma_f32_16x16x32_bf16 v[40:43], v[146:149], v[214:217], v[40:43]
  v_add_f32_dpp v246, v244, v37 wave_shl:1 row_mask:0xf bank_mask:0xf
  ds_read_u16_d16_hi v252, v111 offset:3456
  v_mfma_f32_16x16x32_bf16 v[40:43], v[150:153], v[218:221], v[40:43]
  v_add_f32_dpp v248, v246, v38 wave_shl:1 row_mask:0xf bank_mask:0xf
  ds_read_u16_d16_hi v253, v111 offset:3328
  v_mfma_f32_16x16x32_bf16 v[40:43], v[154:157], v[222:225], v[40:43]
  buffer_load_dwordx4 a[40:43], v2, s[48:51], s37 offen offset:2048 sc1
  v_add_f32_dpp v251, v248, v39 wave_shl:1 row_mask:0xf bank_mask:0xf
  v_mfma_f32_16x16x32_bf16 v[40:43], v[158:161], v[226:229], v[40:43]
  s_waitcnt vmcnt(7)
  buffer_store_dword v15, v7, s[48:51], s12 offen sc1
  v_mfma_f32_16x16x32_bf16 v[40:43], v[162:165], v[230:233], v[40:43]
  v_mfma_f32_16x16x32_bf16 v[40:43], v[166:169], v[234:237], v[40:43]
  v_mfma_f32_16x16x32_bf16 v[40:43], v[170:173], v[238:241], v[40:43]
  v_mfma_f32_16x16x32_bf16 v[44:47], v[114:117], v[184:187], 0
  buffer_load_dwordx4 a[44:47], v2, s[48:51], s37 offen offset:3072 sc1
  v_mfma_f32_16x16x32_bf16 v[44:47], v[118:121], v[188:191], v[44:47]
  v_mfma_f32_16x16x32_bf16 v[44:47], v[122:125], v[192:195], v[44:47]
  v_mfma_f32_16x16x32_bf16 v[44:47], v[126:129], v[196:199], v[44:47]
  v_mfma_f32_16x16x32_bf16 v[44:47], v[130:133], v[200:203], v[44:47]
  v_mfma_f32_16x16x32_bf16 v[44:47], v[134:137], v[204:207], v[44:47]
  s_add_u32 s37, s37, 4096
  buffer_load_dwordx4 a[48:51], v2, s[48:51], s37 offen offset:0 sc1
  v_mfma_f32_16x16x32_bf16 v[44:47], v[138:141], v[208:211], v[44:47]
  v_add_f32_dpp v247, v244, v41 wave_rol:1 row_mask:0xf bank_mask:0xf
  v_cvt_pk_bf16_f32 v255, v250, v251
  v_mfma_f32_16x16x32_bf16 v[44:47], v[142:145], v[212:215], v[44:47]
  s_waitcnt lgkmcnt(3)
  v_fma_f32 v245, v254, v108, v40
  v_mfma_f32_16x16x32_bf16 v[44:47], v[146:149], v[216:219], v[44:47]
  v_add_f32_dpp v249, v246, v42 wave_rol:1 row_mask:0xf bank_mask:0xf
  v_add_f32_dpp v250, v248, v43 wave_rol:1 row_mask:0xf bank_mask:0xf
  v_mfma_f32_16x16x32_bf16 v[44:47], v[150:153], v[220:223], v[44:47]
  v_add_f32_dpp v247, v245, v41 wave_shl:1 row_mask:0xf bank_mask:0xf
  ds_write_b16 v112, v255 offset:4096
  v_mfma_f32_16x16x32_bf16 v[44:47], v[154:157], v[224:227], v[44:47]
  buffer_load_dwordx4 a[52:55], v2, s[48:51], s37 offen offset:1024 sc1
  v_add_f32_dpp v249, v247, v42 wave_shl:1 row_mask:0xf bank_mask:0xf
  v_mfma_f32_16x16x32_bf16 v[44:47], v[158:161], v[228:231], v[44:47]
  ds_write_b16_d16_hi v112, v255 offset:3968
  v_add_f32_dpp v250, v249, v43 wave_shl:1 row_mask:0xf bank_mask:0xf
  v_mfma_f32_16x16x32_bf16 v[44:47], v[162:165], v[232:235], v[44:47]
  v_mfma_f32_16x16x32_bf16 v[44:47], v[166:169], v[236:239], v[44:47]
  v_mfma_f32_16x16x32_bf16 v[44:47], v[170:173], v[240:243], v[44:47]
  v_mfma_f32_16x16x32_bf16 v[32:35], v[114:117], v[186:189], 0
  buffer_load_dwordx4 a[56:59], v2, s[48:51], s37 offen offset:2048 sc1
  v_mfma_f32_16x16x32_bf16 v[32:35], v[118:121], v[190:193], v[32:35]
  v_mfma_f32_16x16x32_bf16 v[32:35], v[122:125], v[194:197], v[32:35]
  v_mfma_f32_16x16x32_bf16 v[32:35], v[126:129], v[198:201], v[32:35]
  v_mfma_f32_16x16x32_bf16 v[32:35], v[130:133], v[202:205], v[32:35]
  v_mfma_f32_16x16x32_bf16 v[32:35], v[134:137], v[206:209], v[32:35]
  buffer_load_dwordx4 a[60:63], v2, s[48:51], s37 offen offset:3072 sc1
  v_add_f32_dpp v246, v245, v45 wave_rol:1 row_mask:0xf bank_mask:0xf
  v_mfma_f32_16x16x32_bf16 v[32:35], v[138:141], v[210:213], v[32:35]
  s_waitcnt lgkmcnt(4)
  v_fma_f32 v244, v109, v108, v44
  v_mfma_f32_16x16x32_bf16 v[32:35], v[142:145], v[214:217], v[32:35]
  v_add_f32_dpp v248, v247, v46 wave_rol:1 row_mask:0xf bank_mask:0xf
  v_add_f32_dpp v251, v249, v47 wave_rol:1 row_mask:0xf bank_mask:0xf
  v_mfma_f32_16x16x32_bf16 v[32:35], v[146:149], v[218:221], v[32:35]
  v_add_f32_dpp v246, v244, v45 wave_shl:1 row_mask:0xf bank_mask:0xf
  ds_read_u16_d16_hi v254, v111 offset:3200
  v_mfma_f32_16x16x32_bf16 v[32:35], v[150:153], v[222:225], v[32:35]
  v_add_f32_dpp v248, v246, v46 wave_shl:1 row_mask:0xf bank_mask:0xf
  ds_read_u16_d16_hi v109, v111 offset:3072
  v_mfma_f32_16x16x32_bf16 v[32:35], v[154:157], v[226:229], v[32:35]
  s_add_u32 s37, s37, 4096
  buffer_load_dwordx4 a[64:67], v2, s[48:51], s37 offen offset:0 sc1
  v_mfma_f32_16x16x32_bf16 v[32:35], v[158:161], v[230:233], v[32:35]
  v_add_f32_dpp v251, v248, v47 wave_shl:1 row_mask:0xf bank_mask:0xf
  v_mfma_f32_16x16x32_bf16 v[32:35], v[162:165], v[234:237], v[32:35]
  v_mfma_f32_16x16x32_bf16 v[32:35], v[166:169], v[238:241], v[32:35]
  v_mfma_f32_16x16x32_bf16 v[36:39], v[114:117], v[188:191], 0
  v_mfma_f32_16x16x32_bf16 v[36:39], v[118:121], v[192:195], v[36:39]
  buffer_load_dwordx4 a[68:71], v2, s[48:51], s37 offen offset:1024 sc1
  v_mfma_f32_16x16x32_bf16 v[36:39], v[122:125], v[196:199], v[36:39]
  v_mfma_f32_16x16x32_bf16 v[36:39], v[126:129], v[200:203], v[36:39]
  v_mfma_f32_16x16x32_bf16 v[36:39], v[130:133], v[204:207], v[36:39]
  v_mfma_f32_16x16x32_bf16 v[36:39], v[134:137], v[208:211], v[36:39]
  v_mfma_f32_16x16x32_bf16 v[36:39], v[138:141], v[212:215], v[36:39]
  buffer_load_dwordx4 a[72:75], v2, s[48:51], s37 offen offset:2048 sc1
  v_add_f32_dpp v247, v244, v33 wave_rol:1 row_mask:0xf bank_mask:0xf
  v_mfma_f32_16x16x32_bf16 v[36:39], v[142:145], v[216:219], v[36:39]
  v_cvt_pk_bf16_f32 v255, v250, v251
  s_waitcnt lgkmcnt(5)
  v_fma_f32 v245, v252, v108, v32
  v_mfma_f32_16x16x32_bf16 v[36:39], v[146:149], v[220:223], v[36:39]
  v_add_f32_dpp v249, v246, v34 wave_rol:1 row_mask:0xf bank_mask:0xf
  v_add_f32_dpp v250, v248, v35 wave_rol:1 row_mask:0xf bank_mask:0xf
  v_mfma_f32_16x16x32_bf16 v[36:39], v[150:153], v[224:227], v[36:39]
  v_add_f32_dpp v247, v245, v33 wave_shl:1 row_mask:0xf bank_mask:0xf
  ds_write_b16 v112, v255 offset:3840
  v_mfma_f32_16x16x32_bf16 v[36:39], v[154:157], v[228:231], v[36:39]
  v_add_f32_dpp v249, v247, v34 wave_shl:1 row_mask:0xf bank_mask:0xf
  ds_write_b16_d16_hi v112, v255 offset:3712
  v_mfma_f32_16x16x32_bf16 v[36:39], v[158:161], v[232:235], v[36:39]
  buffer_load_dwordx4 a[76:79], v2, s[48:51], s37 offen offset:3072 sc1
  v_add_f32_dpp v250, v249, v35 wave_shl:1 row_mask:0xf bank_mask:0xf
  v_mfma_f32_16x16x32_bf16 v[36:39], v[162:165], v[236:239], v[36:39]
  v_mfma_f32_16x16x32_bf16 v[36:39], v[166:169], v[240:243], v[36:39]
  v_mfma_f32_16x16x32_bf16 v[40:43], v[114:117], v[190:193], 0
  v_mfma_f32_16x16x32_bf16 v[40:43], v[118:121], v[194:197], v[40:43]
  v_mfma_f32_16x16x32_bf16 v[40:43], v[122:125], v[198:201], v[40:43]
  s_add_u32 s37, s37, 4096
  buffer_load_dwordx4 a[80:83], v2, s[48:51], s37 offen offset:0 sc1
  v_mfma_f32_16x16x32_bf16 v[40:43], v[126:129], v[202:205], v[40:43]
  v_mfma_f32_16x16x32_bf16 v[40:43], v[130:133], v[206:209], v[40:43]
  v_mfma_f32_16x16x32_bf16 v[40:43], v[134:137], v[210:213], v[40:43]
  v_add_f32_dpp v246, v245, v37 wave_rol:1 row_mask:0xf bank_mask:0xf
  s_waitcnt lgkmcnt(6)
  v_fma_f32 v244, v253, v108, v36
  v_mfma_f32_16x16x32_bf16 v[40:43], v[138:141], v[214:217], v[40:43]
  v_add_f32_dpp v248, v247, v38 wave_rol:1 row_mask:0xf bank_mask:0xf
  v_add_f32_dpp v251, v249, v39 wave_rol:1 row_mask:0xf bank_mask:0xf
  v_mfma_f32_16x16x32_bf16 v[40:43], v[142:145], v[218:221], v[40:43]
  buffer_load_dwordx4 a[84:87], v2, s[48:51], s37 offen offset:1024 sc1
  v_add_f32_dpp v246, v244, v37 wave_shl:1 row_mask:0xf bank_mask:0xf
  v_mfma_f32_16x16x32_bf16 v[40:43], v[146:149], v[222:225], v[40:43]
  ds_read_u16_d16_hi v252, v111 offset:2944
  v_add_f32_dpp v248, v246, v38 wave_shl:1 row_mask:0xf bank_mask:0xf
  v_mfma_f32_16x16x32_bf16 v[40:43], v[150:153], v[226:229], v[40:43]
  ds_read_u16_d16_hi v253, v111 offset:2816
  v_add_f32_dpp v251, v248, v39 wave_shl:1 row_mask:0xf bank_mask:0xf
  v_mfma_f32_16x16x32_bf16 v[40:43], v[154:157], v[230:233], v[40:43]
  v_mfma_f32_16x16x32_bf16 v[40:43], v[158:161], v[234:237], v[40:43]
  v_mfma_f32_16x16x32_bf16 v[40:43], v[162:165], v[238:241], v[40:43]
  buffer_load_dwordx4 a[88:91], v2, s[48:51], s37 offen offset:2048 sc1
  v_mfma_f32_16x16x32_bf16 v[44:47], v[114:117], v[192:195], 0
  v_mfma_f32_16x16x32_bf16 v[44:47], v[118:121], v[196:199], v[44:47]
  v_mfma_f32_16x16x32_bf16 v[44:47], v[122:125], v[200:203], v[44:47]
  v_mfma_f32_16x16x32_bf16 v[44:47], v[126:129], v[204:207], v[44:47]
  v_mfma_f32_16x16x32_bf16 v[44:47], v[130:133], v[208:211], v[44:47]
  buffer_load_dwordx4 a[92:95], v2, s[48:51], s37 offen offset:3072 sc1
  v_mfma_f32_16x16x32_bf16 v[44:47], v[134:137], v[212:215], v[44:47]
  v_add_f32_dpp v247, v244, v41 wave_rol:1 row_mask:0xf bank_mask:0xf
  v_cvt_pk_bf16_f32 v255, v250, v251
  v_mfma_f32_16x16x32_bf16 v[44:47], v[138:141], v[216:219], v[44:47]
  s_waitcnt lgkmcnt(5)
  v_fma_f32 v245, v254, v108, v40
  v_mfma_f32_16x16x32_bf16 v[44:47], v[142:145], v[220:223], v[44:47]
  v_add_f32_dpp v249, v246, v42 wave_rol:1 row_mask:0xf bank_mask:0xf
  v_add_f32_dpp v250, v248, v43 wave_rol:1 row_mask:0xf bank_mask:0xf
  v_mfma_f32_16x16x32_bf16 v[44:47], v[146:149], v[224:227], v[44:47]
  v_add_f32_dpp v247, v245, v41 wave_shl:1 row_mask:0xf bank_mask:0xf
  ds_write_b16 v112, v255 offset:3584
  v_mfma_f32_16x16x32_bf16 v[44:47], v[150:153], v[228:231], v[44:47]
  s_add_u32 s37, s37, 4096
  buffer_load_dwordx4 a[96:99], v2, s[48:51], s37 offen offset:0 sc1
  v_mfma_f32_16x16x32_bf16 v[44:47], v[154:157], v[232:235], v[44:47]
  v_add_f32_dpp v249, v247, v42 wave_shl:1 row_mask:0xf bank_mask:0xf
  ds_write_b16_d16_hi v112, v255 offset:3456
  v_mfma_f32_16x16x32_bf16 v[44:47], v[158:161], v[236:239], v[44:47]
  v_add_f32_dpp v250, v249, v43 wave_shl:1 row_mask:0xf bank_mask:0xf
  v_mfma_f32_16x16x32_bf16 v[44:47], v[162:165], v[240:243], v[44:47]
  v_mfma_f32_16x16x32_bf16 v[32:35], v[114:117], v[194:197], 0
  v_mfma_f32_16x16x32_bf16 v[32:35], v[118:121], v[198:201], v[32:35]
  buffer_load_dwordx4 a[100:103], v2, s[48:51], s37 offen offset:1024 sc1
  v_mfma_f32_16x16x32_bf16 v[32:35], v[122:125], v[202:205], v[32:35]
  v_mfma_f32_16x16x32_bf16 v[32:35], v[126:129], v[206:209], v[32:35]
  v_mfma_f32_16x16x32_bf16 v[32:35], v[130:133], v[210:213], v[32:35]
  v_mfma_f32_16x16x32_bf16 v[32:35], v[134:137], v[214:217], v[32:35]
  v_mfma_f32_16x16x32_bf16 v[32:35], v[138:141], v[218:221], v[32:35]
  buffer_load_dwordx4 a[104:107], v2, s[48:51], s37 offen offset:2048 sc1
  v_add_f32_dpp v246, v245, v45 wave_rol:1 row_mask:0xf bank_mask:0xf
  v_mfma_f32_16x16x32_bf16 v[32:35], v[142:145], v[222:225], v[32:35]
  s_waitcnt lgkmcnt(6)
  v_fma_f32 v244, v109, v108, v44
  v_mfma_f32_16x16x32_bf16 v[32:35], v[146:149], v[226:229], v[32:35]
  v_add_f32_dpp v248, v247, v46 wave_rol:1 row_mask:0xf bank_mask:0xf
  v_add_f32_dpp v251, v249, v47 wave_rol:1 row_mask:0xf bank_mask:0xf
  v_mfma_f32_16x16x32_bf16 v[32:35], v[150:153], v[230:233], v[32:35]
  buffer_load_dwordx2 v[104:105], v8, s[48:51], s13 offen sc1
  v_add_f32_dpp v246, v244, v45 wave_shl:1 row_mask:0xf bank_mask:0xf
  v_mfma_f32_16x16x32_bf16 v[32:35], v[154:157], v[234:237], v[32:35]
  ds_read_u16_d16_hi v254, v111 offset:2688
  v_add_f32_dpp v248, v246, v46 wave_shl:1 row_mask:0xf bank_mask:0xf
  v_mfma_f32_16x16x32_bf16 v[32:35], v[158:161], v[238:241], v[32:35]
  buffer_load_dwordx4 a[108:111], v2, s[48:51], s37 offen offset:3072 sc1
  ds_read_u16_d16_hi v109, v111 offset:2560
  v_mfma_f32_16x16x32_bf16 v[36:39], v[114:117], v[196:199], 0
  v_add_f32_dpp v251, v248, v47 wave_shl:1 row_mask:0xf bank_mask:0xf
  v_mfma_f32_16x16x32_bf16 v[36:39], v[118:121], v[200:203], v[36:39]
  v_mfma_f32_16x16x32_bf16 v[36:39], v[122:125], v[204:207], v[36:39]
  v_mfma_f32_16x16x32_bf16 v[36:39], v[126:129], v[208:211], v[36:39]
  v_mfma_f32_16x16x32_bf16 v[36:39], v[130:133], v[212:215], v[36:39]
  s_add_u32 s37, s37, 4096
  buffer_load_dwordx4 a[112:115], v2, s[48:51], s37 offen offset:0 sc1
  v_mfma_f32_16x16x32_bf16 v[36:39], v[134:137], v[216:219], v[36:39]
  v_add_f32_dpp v247, v244, v33 wave_rol:1 row_mask:0xf bank_mask:0xf
  v_cvt_pk_bf16_f32 v255, v250, v251
  v_mfma_f32_16x16x32_bf16 v[36:39], v[138:141], v[220:223], v[36:39]
  s_waitcnt lgkmcnt(5)
  v_fma_f32 v245, v252, v108, v32
  v_mfma_f32_16x16x32_bf16 v[36:39], v[142:145], v[224:227], v[36:39]
  v_add_f32_dpp v249, v246, v34 wave_rol:1 row_mask:0xf bank_mask:0xf
  v_add_f32_dpp v250, v248, v35 wave_rol:1 row_mask:0xf bank_mask:0xf
  v_mfma_f32_16x16x32_bf16 v[36:39], v[146:149], v[228:231], v[36:39]
  v_add_f32_dpp v247, v245, v33 wave_shl:1 row_mask:0xf bank_mask:0xf
  ds_write_b16 v112, v255 offset:3328
  v_mfma_f32_16x16x32_bf16 v[36:39], v[150:153], v[232:235], v[36:39]
  buffer_load_dwordx4 a[116:119], v2, s[48:51], s37 offen offset:1024 sc1
  v_add_f32_dpp v249, v247, v34 wave_shl:1 row_mask:0xf bank_mask:0xf
  v_mfma_f32_16x16x32_bf16 v[36:39], v[154:157], v[236:239], v[36:39]
  ds_write_b16_d16_hi v112, v255 offset:3200
  v_add_f32_dpp v250, v249, v35 wave_shl:1 row_mask:0xf bank_mask:0xf
  v_mfma_f32_16x16x32_bf16 v[36:39], v[158:161], v[240:243], v[36:39]
  v_mfma_f32_16x16x32_bf16 v[40:43], v[114:117], v[198:201], 0
  v_mfma_f32_16x16x32_bf16 v[40:43], v[118:121], v[202:205], v[40:43]
  v_mfma_f32_16x16x32_bf16 v[40:43], v[122:125], v[206:209], v[40:43]
  buffer_load_dwordx4 a[120:123], v2, s[48:51], s37 offen offset:2048 sc1
  v_mfma_f32_16x16x32_bf16 v[40:43], v[126:129], v[210:213], v[40:43]
  v_mfma_f32_16x16x32_bf16 v[40:43], v[130:133], v[214:217], v[40:43]
  v_mfma_f32_16x16x32_bf16 v[40:43], v[134:137], v[218:221], v[40:43]
  v_mfma_f32_16x16x32_bf16 v[40:43], v[138:141], v[222:225], v[40:43]
  v_add_f32_dpp v246, v245, v37 wave_rol:1 row_mask:0xf bank_mask:0xf
  s_waitcnt lgkmcnt(6)
  v_fma_f32 v244, v253, v108, v36
  v_mfma_f32_16x16x32_bf16 v[40:43], v[142:145], v[226:229], v[40:43]
  buffer_load_dwordx4 a[124:127], v2, s[48:51], s37 offen offset:3072 sc1
  v_add_f32_dpp v248, v247, v38 wave_rol:1 row_mask:0xf bank_mask:0xf
  v_mfma_f32_16x16x32_bf16 v[40:43], v[146:149], v[230:233], v[40:43]
  v_add_f32_dpp v251, v249, v39 wave_rol:1 row_mask:0xf bank_mask:0xf
  v_add_f32_dpp v246, v244, v37 wave_shl:1 row_mask:0xf bank_mask:0xf
  v_mfma_f32_16x16x32_bf16 v[40:43], v[150:153], v[234:237], v[40:43]
  ds_read_u16_d16_hi v252, v111 offset:2432
  v_add_f32_dpp v248, v246, v38 wave_shl:1 row_mask:0xf bank_mask:0xf
  v_mfma_f32_16x16x32_bf16 v[40:43], v[154:157], v[238:241], v[40:43]
  ds_read_u16_d16_hi v253, v111 offset:2304
  v_add_f32_dpp v251, v248, v39 wave_shl:1 row_mask:0xf bank_mask:0xf
  v_mfma_f32_16x16x32_bf16 v[44:47], v[114:117], v[200:203], 0
  v_cvt_pk_bf16_f32 v255, v250, v251
  ds_write_b16 v112, v255 offset:3072
  v_mfma_f32_16x16x32_bf16 v[44:47], v[118:121], v[204:207], v[44:47]
  s_add_u32 s37, s37, 4096
  buffer_load_dwordx4 a[128:131], v2, s[48:51], s37 offen offset:0 sc1
  v_mfma_f32_16x16x32_bf16 v[44:47], v[122:125], v[208:211], v[44:47]
  ds_write_b16_d16_hi v112, v255 offset:2944
  ds_read_b128 v[96:99], v113 offset:3194
  v_mfma_f32_16x16x32_bf16 v[44:47], v[126:129], v[212:215], v[44:47]
  v_add_f32_dpp v247, v244, v41 wave_rol:1 row_mask:0xf bank_mask:0xf
  s_waitcnt lgkmcnt(8)
  v_fma_f32 v245, v254, v108, v40
  v_mfma_f32_16x16x32_bf16 v[44:47], v[130:133], v[216:219], v[44:47]
  s_waitcnt vmcnt(6)
  v_cmp_ne_u32 vcc, s60, v104
  s_cbranch_vccz Lgot_6
Lpoll_5:
  s_sleep 1
  buffer_load_dwordx2 v[104:105], v8, s[48:51], s13 offen sc1
  s_waitcnt vmcnt(0)
  s_sub_u32 s79, s79, 1
  s_cbranch_scc1 Lend
  v_cmp_ne_u32 vcc, s60, v104
  s_cbranch_vccnz Lpoll_5
Lgot_6:
  v_mov_b32 v6, v105
  v_mfma_f32_16x16x32_bf16 v[44:47], v[134:137], v[220:223], v[44:47]
  v_add_f32_dpp v249, v246, v42 wave_rol:1 row_mask:0xf bank_mask:0xf
  v_add_f32_dpp v250, v248, v43 wave_rol:1 row_mask:0xf bank_mask:0xf
  v_mfma_f32_16x16x32_bf16 v[44:47], v[138:141], v[224:227], v[44:47]
  buffer_load_dwordx4 v[48:51], v2, s[48:51], s16 offen offset:0 sc1
  v_add_f32_dpp v247, v245, v41 wave_shl:1 row_mask:0xf bank_mask:0xf
  v_mfma_f32_16x16x32_bf16 v[44:47], v[142:145], v[228:231], v[44:47]
  v_mfma_f32_16x16x32_bf16 v[44:47], v[146:149], v[232:235], v[44:47]
  v_add_f32_dpp v249, v247, v42 wave_shl:1 row_mask:0xf bank_mask:0xf
  v_mfma_f32_16x16x32_bf16 v[44:47], v[150:153], v[236:239], v[44:47]
  v_mfma_f32_16x16x32_bf16 v[44:47], v[154:157], v[240:243], v[44:47]
  v_add_f32_dpp v250, v249, v43 wave_shl:1 row_mask:0xf bank_mask:0xf
  s_waitcnt lgkmcnt(0)
  buffer_store_dwordx4 v[96:99], v2, s[48:51], s61 offen offset:3072 sc1
  v_mfma_f32_16x16x32_bf16 v[32:35], v[114:117], v[202:205], 0
  buffer_load_dwordx4 v[52:55], v2, s[48:51], s16 offen offset:1024 sc1
  v_mfma_f32_16x16x32_bf16 v[32:35], v[118:121], v[206:209], v[32:35]
  v_mfma_f32_16x16x32_bf16 v[32:35], v[122:125], v[210:213], v[32:35]
  v_mfma_f32_16x16x32_bf16 v[32:35], v[126:129], v[214:217], v[32:35]
  v_add_f32_dpp v246, v245, v45 wave_rol:1 row_mask:0xf bank_mask:0xf
  v_fma_f32 v244, v109, v108, v44
  v_mfma_f32_16x16x32_bf16 v[32:35], v[130:133], v[218:221], v[32:35]
  v_add_f32_dpp v248, v247, v46 wave_rol:1 row_mask:0xf bank_mask:0xf
  v_add_f32_dpp v251, v249, v47 wave_rol:1 row_mask:0xf bank_mask:0xf
  v_mfma_f32_16x16x32_bf16 v[32:35], v[134:137], v[222:225], v[32:35]
  buffer_load_dwordx4 v[56:59], v2, s[48:51], s16 offen offset:2048 sc1
  v_add_f32_dpp v246, v244, v45 wave_shl:1 row_mask:0xf bank_mask:0xf
  v_mfma_f32_16x16x32_bf16 v[32:35], v[138:141], v[226:229], v[32:35]
  ds_read_u16_d16_hi v254, v111 offset:2176
  v_add_f32_dpp v248, v246, v46 wave_shl:1 row_mask:0xf bank_mask:0xf
  v_mfma_f32_16x16x32_bf16 v[32:35], v[142:145], v[230:233], v[32:35]
  ds_read_u16_d16_hi v109, v111 offset:2048
  v_add_f32_dpp v251, v248, v47 wave_shl:1 row_mask:0xf bank_mask:0xf
  v_mfma_f32_16x16x32_bf16 v[32:35], v[146:149], v[234:237], v[32:35]
  v_mfma_f32_16x16x32_bf16 v[32:35], v[150:153], v[238:241], v[32:35]
  v_mfma_f32_16x16x32_bf16 v[36:39], v[114:117], v[204:207], 0
  buffer_load_dwordx4 v[60:63], v2, s[48:51], s16 offen offset:3072 sc1
  v_mfma_f32_16x16x32_bf16 v[36:39], v[118:121], v[208:211], v[36:39]
  v_mfma_f32_16x16x32_bf16 v[36:39], v[122:125], v[212:215], v[36:39]
  v_mfma_f32_16x16x32_bf16 v[36:39], v[126:129], v[216:219], v[36:39]
  v_mfma_f32_16x16x32_bf16 v[36:39], v[130:133], v[220:223], v[36:39]
  v_mfma_f32_16x16x32_bf16 v[36:39], v[134:137], v[224:227], v[36:39]
  buffer_load_dwordx4 v[64:67], v4, s[48:51], s16 offen offset:0 sc1
  v_add_f32_dpp v247, v244, v33 wave_rol:1 row_mask:0xf bank_mask:0xf
  v_mfma_f32_16x16x32_bf16 v[36:39], v[138:141], v[228:231], v[36:39]
  v_cvt_pk_bf16_f32 v255, v250, v251
  v_fma_f32 v245, v252, v108, v32
  v_mfma_f32_16x16x32_bf16 v[36:39], v[142:145], v[232:235], v[36:39]
  v_add_f32_dpp v249, v246, v34 wave_rol:1 row_mask:0xf bank_mask:0xf
  v_add_f32_dpp v250, v248, v35 wave_rol:1 row_mask:0xf bank_mask:0xf
  v_mfma_f32_16x16x32_bf16 v[36:39], v[146:149], v[236:239], v[36:39]
  v_add_f32_dpp v247, v245, v33 wave_shl:1 row_mask:0xf bank_mask:0xf
  ds_write_b16 v112, v255 offset:2816
  v_mfma_f32_16x16x32_bf16 v[36:39], v[150:153], v[240:243], v[36:39]
  v_add_f32_dpp v249, v247, v34 wave_shl:1 row_mask:0xf bank_mask:0xf
  ds_write_b16_d16_hi v112, v255 offset:2688
  v_mfma_f32_16x16x32_bf16 v[40:43], v[114:117], v[206:209], 0
  buffer_load_dwordx4 v[68:71], v4, s[48:51], s16 offen offset:1024 sc1
  v_add_f32_dpp v250, v249, v35 wave_shl:1 row_mask:0xf bank_mask:0xf
  v_mfma_f32_16x16x32_bf16 v[40:43], v[118:121], v[210:213], v[40:43]
  v_mfma_f32_16x16x32_bf16 v[40:43], v[122:125], v[214:217], v[40:43]
  v_mfma_f32_16x16x32_bf16 v[40:43], v[126:129], v[218:221], v[40:43]
  v_add_f32_dpp v246, v245, v37 wave_rol:1 row_mask:0xf bank_mask:0xf
  v_fma_f32 v244, v253, v108, v36
  v_mfma_f32_16x16x32_bf16 v[40:43], v[130:133], v[222:225], v[40:43]
  v_add_f32_dpp v248, v247, v38 wave_rol:1 row_mask:0xf bank_mask:0xf
  v_add_f32_dpp v251, v249, v39 wave_rol:1 row_mask:0xf bank_mask:0xf
  v_mfma_f32_16x16x32_bf16 v[40:43], v[134:137], v[226:229], v[40:43]
  buffer_load_dwordx4 v[72:75], v4, s[48:51], s16 offen offset:2048 sc1
  v_add_f32_dpp v246, v244, v37 wave_shl:1 row_mask:0xf bank_mask:0xf
  v_mfma_f32_16x16x32_bf16 v[40:43], v[138:141], v[230:233], v[40:43]
  ds_read_u16_d16_hi v252, v111 offset:1920
  v_add_f32_dpp v248, v246, v38 wave_shl:1 row_mask:0xf bank_mask:0xf
  v_mfma_f32_16x16x32_bf16 v[40:43], v[142:145], v[234:237], v[40:43]
  v_mfma_f32_16x16x32_bf16 v[40:43], v[146:149], v[238:241], v[40:43]
  v_add_f32_dpp v251, v248, v39 wave_shl:1 row_mask:0xf bank_mask:0xf
  v_mfma_f32_16x16x32_bf16 v[44:47], v[114:117], v[208:211], 0
  v_mfma_f32_16x16x32_bf16 v[44:47], v[118:121], v[212:215], v[44:47]
  buffer_load_dwordx4 v[76:79], v4, s[48:51], s16 offen offset:3072 sc1
  v_mfma_f32_16x16x32_bf16 v[44:47], v[122:125], v[216:219], v[44:47]
  v_mfma_f32_16x16x32_bf16 v[44:47], v[126:129], v[220:223], v[44:47]
  v_mfma_f32_16x16x32_bf16 v[44:47], v[130:133], v[224:227], v[44:47]
  v_mfma_f32_16x16x32_bf16 v[44:47], v[134:137], v[228:231], v[44:47]
  v_add_f32_dpp v247, v244, v41 wave_rol:1 row_mask:0xf bank_mask:0xf
  v_cvt_pk_bf16_f32 v255, v250, v251
  v_mfma_f32_16x16x32_bf16 v[44:47], v[138:141], v[232:235], v[44:47]
  buffer_load_dwordx4 v[80:83], v5, s[48:51], s16 offen offset:0 sc1
  s_waitcnt lgkmcnt(4)
  v_fma_f32 v245, v254, v108, v40
  v_mfma_f32_16x16x32_bf16 v[44:47], v[142:145], v[236:239], v[44:47]
  v_add_f32_dpp v249, v246, v42 wave_rol:1 row_mask:0xf bank_mask:0xf
  v_add_f32_dpp v250, v248, v43 wave_rol:1 row_mask:0xf bank_mask:0xf
  v_mfma_f32_16x16x32_bf16 v[44:47], v[146:149], v[240:243], v[44:47]
  v_add_f32_dpp v247, v245, v41 wave_shl:1 row_mask:0xf bank_mask:0xf
  ds_write_b16 v112, v255 offset:2560
  v_mfma_f32_16x16x32_bf16 v[32:35], v[114:117], v[210:213], 0
  v_add_f32_dpp v249, v247, v42 wave_shl:1 row_mask:0xf bank_mask:0xf
  ds_write_b16_d16_hi v112, v255 offset:2432
  v_mfma_f32_16x16x32_bf16 v[32:35], v[118:121], v[214:217], v[32:35]
  v_add_f32_dpp v250, v249, v43 wave_shl:1 row_mask:0xf bank_mask:0xf
  v_mfma_f32_16x16x32_bf16 v[32:35], v[122:125], v[218:221], v[32:35]
  buffer_load_dwordx4 v[84:87], v5, s[48:51], s16 offen offset:1024 sc1
  v_add_f32_dpp v246, v245, v45 wave_rol:1 row_mask:0xf bank_mask:0xf
  v_mfma_f32_16x16x32_bf16 v[32:35], v[126:129], v[222:225], v[32:35]
  s_waitcnt lgkmcnt(5)
  v_fma_f32 v244, v109, v108, v44
  v_mfma_f32_16x16x32_bf16 v[32:35], v[130:133], v[226:229], v[32:35]
  v_add_f32_dpp v248, v247, v46 wave_rol:1 row_mask:0xf bank_mask:0xf
  v_add_f32_dpp v251, v249, v47 wave_rol:1 row_mask:0xf bank_mask:0xf
  v_mfma_f32_16x16x32_bf16 v[32:35], v[134:137], v[230:233], v[32:35]
  v_add_f32_dpp v246, v244, v45 wave_shl:1 row_mask:0xf bank_mask:0xf
  v_mfma_f32_16x16x32_bf16 v[32:35], v[138:141], v[234:237], v[32:35]
  v_mfma_f32_16x16x32_bf16 v[32:35], v[142:145], v[238:241], v[32:35]
  buffer_load_dwordx4 a[132:135], v2, s[48:51], s37 offen offset:1024 sc1
  v_add_f32_dpp v248, v246, v46 wave_shl:1 row_mask:0xf bank_mask:0xf
  s_waitcnt vmcnt(11)
  v_mfma_f32_16x16x32_bf16 v[8:11], a[160:163], v[48:51], 0
  v_add_f32_dpp v251, v248, v47 wave_shl:1 row_mask:0xf bank_mask:0xf
  v_mfma_f32_16x16x32_bf16 v[12:15], a[164:167], v[48:51], 0
  v_mfma_f32_16x16x32_bf16 v[16:19], a[168:171], v[48:51], 0
  v_mfma_f32_16x16x32_bf16 v[20:23], a[172:175], v[48:51], 0
  v_add_f32_dpp v247, v244, v33 wave_rol:1 row_mask:0xf bank_mask:0xf
  v_cvt_pk_bf16_f32 v255, v250, v251
  v_mfma_f32_16x16x32_bf16 v[24:27], a[176:179], v[48:51], 0
  buffer_load_dwordx4 a[136:139], v2, s[48:51], s37 offen offset:2048 sc1
  s_waitcnt lgkmcnt(2)
  v_fma_f32 v245, v252, v108, v32
  s_waitcnt vmcnt(10)
  v_mfma_f32_16x16x32_bf16 v[8:11], a[180:183], v[52:55], v[8:11]
  v_add_f32_dpp v249, v246, v34 wave_rol:1 row_mask:0xf bank_mask:0xf
  v_mfma_f32_16x16x32_bf16 v[12:15], a[184:187], v[52:55], v[12:15]
  v_add_f32_dpp v250, v248, v35 wave_rol:1 row_mask:0xf bank_mask:0xf
  v_add_f32_dpp v247, v245, v33 wave_shl:1 row_mask:0xf bank_mask:0xf
  v_mfma_f32_16x16x32_bf16 v[16:19], a[188:191], v[52:55], v[16:19]
  ds_write_b16 v112, v255 offset:2304
  v_add_f32_dpp v249, v247, v34 wave_shl:1 row_mask:0xf bank_mask:0xf
  v_mfma_f32_16x16x32_bf16 v[20:23], a[192:195], v[52:55], v[20:23]
  ds_write_b16_d16_hi v112, v255 offset:2176
  v_add_f32_dpp v250, v249, v35 wave_shl:1 row_mask:0xf bank_mask:0xf
  v_mfma_f32_16x16x32_bf16 v[24:27], a[196:199], v[52:55], v[24:27]
  buffer_load_dwordx4 a[140:143], v2, s[48:51], s37 offen offset:3072 sc1
  v_cvt_pk_bf16_f32 v255, v250, v250
  s_waitcnt vmcnt(10)
  v_mfma_f32_16x16x32_bf16 v[8:11], a[200:203], v[56:59], v[8:11]
  ds_write_b16 v112, v255 offset:2048
  v_mfma_f32_16x16x32_bf16 v[12:15], a[204:207], v[56:59], v[12:15]
  s_add_u32 s37, s37, 4096
  buffer_load_dwordx4 a[144:147], v2, s[48:51], s37 offen offset:0 sc1
  v_mfma_f32_16x16x32_bf16 v[16:19], a[208:211], v[56:59], v[16:19]
  ds_read_b128 v[100:103], v113 offset:2170
  v_mfma_f32_16x16x32_bf16 v[20:23], a[212:215], v[56:59], v[20:23]
  buffer_load_dwordx4 a[148:151], v2, s[48:51], s37 offen offset:1024 sc1
  v_mfma_f32_16x16x32_bf16 v[24:27], a[216:219], v[56:59], v[24:27]
  s_waitcnt vmcnt(11)
  v_mfma_f32_16x16x32_bf16 v[8:11], a[220:223], v[60:63], v[8:11]
  buffer_load_dwordx4 a[152:155], v2, s[48:51], s37 offen offset:2048 sc1
  v_mfma_f32_16x16x32_bf16 v[12:15], a[224:227], v[60:63], v[12:15]
  s_waitcnt lgkmcnt(0)
  buffer_store_dwordx4 v[100:103], v2, s[48:51], s61 offen offset:2048 sc1
  v_mfma_f32_16x16x32_bf16 v[16:19], a[228:231], v[60:63], v[16:19]
  buffer_load_dwordx4 a[156:159], v2, s[48:51], s37 offen offset:3072 sc1
  v_mfma_f32_16x16x32_bf16 v[20:23], a[232:235], v[60:63], v[20:23]
  v_mfma_f32_16x16x32_bf16 v[24:27], a[236:239], v[60:63], v[24:27]
  buffer_load_dwordx4 v[88:91], v5, s[48:51], s16 offen offset:2048 sc1
  s_waitcnt vmcnt(14)
  v_mfma_f32_16x16x32_bf16 v[8:11], a[0:3], v[64:67], v[8:11]
  v_mfma_f32_16x16x32_bf16 v[12:15], a[4:7], v[64:67], v[12:15]
  buffer_load_dwordx4 v[92:95], v5, s[48:51], s16 offen offset:3072 sc1
  v_mfma_f32_16x16x32_bf16 v[16:19], a[8:11], v[64:67], v[16:19]
  v_mfma_f32_16x16x32_bf16 v[20:23], a[12:15], v[64:67], v[20:23]
  buffer_load_dwordx4 v[174:177], v2, s[48:51], s17 offen offset:0 sc1
  v_mfma_f32_16x16x32_bf16 v[24:27], a[16:19], v[64:67], v[24:27]
  s_waitcnt vmcnt(15)
  v_mfma_f32_16x16x32_bf16 v[8:11], a[20:23], v[68:71], v[8:11]
  buffer_load_dwordx4 v[178:181], v2, s[48:51], s17 offen offset:1024 sc1
  v_mfma_f32_16x16x32_bf16 v[12:15], a[24:27], v[68:71], v[12:15]
  v_mfma_f32_16x16x32_bf16 v[16:19], a[28:31], v[68:71], v[16:19]
  v_mfma_f32_16x16x32_bf16 v[20:23], a[32:35], v[68:71], v[20:23]
  v_mfma_f32_16x16x32_bf16 v[24:27], a[36:39], v[68:71], v[24:27]
  s_waitcnt vmcnt(15)
  v_mfma_f32_16x16x32_bf16 v[8:11], a[40:43], v[72:75], v[8:11]
  buffer_load_dwordx4 v[170:173], v2, s[48:51], s17 offen offset:2048 sc1
  v_mfma_f32_16x16x32_bf16 v[12:15], a[44:47], v[72:75], v[12:15]
  v_mfma_f32_16x16x32_bf16 v[16:19], a[48:51], v[72:75], v[16:19]
  v_mfma_f32_16x16x32_bf16 v[20:23], a[52:55], v[72:75], v[20:23]
  v_mfma_f32_16x16x32_bf16 v[24:27], a[56:59], v[72:75], v[24:27]
  s_waitcnt vmcnt(15)
  v_mfma_f32_16x16x32_bf16 v[8:11], a[60:63], v[76:79], v[8:11]
  buffer_load_dwordx4 v[182:185], v2, s[48:51], s17 offen offset:3072 sc1
  v_mfma_f32_16x16x32_bf16 v[12:15], a[64:67], v[76:79], v[12:15]
  v_mfma_f32_16x16x32_bf16 v[16:19], a[68:71], v[76:79], v[16:19]
  v_mfma_f32_16x16x32_bf16 v[20:23], a[72:75], v[76:79], v[20:23]
  v_mfma_f32_16x16x32_bf16 v[24:27], a[76:79], v[76:79], v[24:27]
  s_nop 7
  s_branch Ljoin
Lnoconv:
  s_branch Lts3
Ltp3:
  s_branch Ltp7
Lts3:
  v_mov_b32 v110, v255
  v_lshlrev_b32 v0, 2, v1
  s_sub_u32 s23, s61, 2176
  v_mfma_f32_16x16x32_bf16 v[32:35], v[114:117], v[210:213], 0
  ds_read_u16_d16_hi v252, v111 offset:1920
  ds_read_u16_d16_hi v253, v111 offset:1792
  ds_read_u16_d16_hi v254, v111 offset:1664
  ds_read_u16_d16_hi v109, v111 offset:1536
  v_mfma_f32_16x16x32_bf16 v[32:35], v[118:121], v[214:217], v[32:35]
  v_mfma_f32_16x16x32_bf16 v[32:35], v[122:125], v[218:221], v[32:35]
  buffer_load_dwordx4 a[8:11], v2, s[48:51], s37 offen offset:2048 sc1
  v_mov_b32 v210, 0
  s_branch Lts4
Ltp4:
  s_branch Ltback
Lts4:
  v_mov_b32 v211, 0
  v_mul_f32 v80, s62, v16
  v_mul_f32 v81, s62, v17
  v_mul_f32 v82, s62, v18
  v_mul_f32 v83, s62, v19
  v_exp_f32 v80, v80
  v_exp_f32 v81, v81
  v_mfma_f32_16x16x32_bf16 v[32:35], v[126:129], v[222:225], v[32:35]
  v_exp_f32 v82, v82
  v_exp_f32 v83, v83
  v_add_f32 v80, 1.0, v80
  v_add_f32 v81, 1.0, v81
  v_add_f32 v82, 1.0, v82
  v_add_f32 v83, 1.0, v83
  v_rcp_f32 v80, v80
  v_rcp_f32 v81, v81
  v_mfma_f32_16x16x32_bf16 v[32:35], v[130:133], v[226:229], v[32:35]
  v_rcp_f32 v82, v82
  v_rcp_f32 v83, v83
  v_mul_f32 v80, v80, v16
  v_mul_f32 v81, v81, v17
  v_mul_f32 v82, v82, v18
  v_mul_f32 v83, v83, v19
  v_cvt_pk_bf16_f32 v96, v80, v81
  v_cvt_pk_bf16_f32 v97, v82, v83
  v_mul_f32 v84, s62, v20
  v_mul_f32 v85, s62, v21
  v_mfma_f32_16x16x32_bf16 v[32:35], v[134:137], v[230:233], v[32:35]
  buffer_load_dwordx4 a[12:15], v2, s[48:51], s37 offen offset:3072 sc1
  v_mul_f32 v86, s62, v22
  v_mul_f32 v87, s62, v23
  v_exp_f32 v84, v84
  v_exp_f32 v85, v85
  v_exp_f32 v86, v86
  v_exp_f32 v87, v87
  v_add_f32 v84, 1.0, v84
  v_mfma_f32_16x16x32_bf16 v[32:35], v[138:141], v[234:237], v[32:35]
  v_add_f32 v85, 1.0, v85
  v_add_f32 v86, 1.0, v86
  v_add_f32 v87, 1.0, v87
  v_rcp_f32 v84, v84
  v_rcp_f32 v85, v85
  v_rcp_f32 v86, v86
  v_rcp_f32 v87, v87
  v_mul_f32 v84, v84, v20
  v_mfma_f32_16x16x32_bf16 v[32:35], v[142:145], v[238:241], v[32:35]
  v_mul_f32 v85, v85, v21
  v_mul_f32 v86, v86, v22
  v_mul_f32 v87, v87, v23
  v_cvt_pk_bf16_f32 v98, v84, v85
  v_cvt_pk_bf16_f32 v99, v86, v87
  buffer_store_dwordx4 v[96:99], v13, s[48:51], s76 offen offset:0 sc1
  v_mul_f32 v80, s62, v24
  v_mul_f32 v81, s62, v25
  v_mul_f32 v82, s62, v26
  v_mul_f32 v83, s62, v27
  v_exp_f32 v80, v80
  v_mfma_f32_16x16x32_bf16 v[36:39], v[114:117], v[212:215], 0
  s_add_u32 s37, s37, 4096
  buffer_load_dwordx4 a[16:19], v2, s[48:51], s37 offen offset:0 sc1
  v_exp_f32 v81, v81
  v_exp_f32 v82, v82
  v_exp_f32 v83, v83
  v_add_f32 v80, 1.0, v80
  v_add_f32 v81, 1.0, v81
  v_add_f32 v82, 1.0, v82
  v_add_f32 v83, 1.0, v83
  v_mfma_f32_16x16x32_bf16 v[36:39], v[118:121], v[216:219], v[36:39]
  v_rcp_f32 v80, v80
  v_rcp_f32 v81, v81
  v_rcp_f32 v82, v82
  v_rcp_f32 v83, v83
  v_mul_f32 v80, v80, v24
  v_mul_f32 v81, v81, v25
  v_mul_f32 v82, v82, v26
  v_mul_f32 v83, v83, v27
  v_mfma_f32_16x16x32_bf16 v[36:39], v[122:125], v[220:223], v[36:39]
  v_cvt_pk_bf16_f32 v100, v80, v81
  v_cvt_pk_bf16_f32 v101, v82, v83
  v_mul_f32 v84, s62, v28
  v_mul_f32 v85, s62, v29
  v_mul_f32 v86, s62, v30
  v_mul_f32 v87, s62, v31
  v_exp_f32 v84, v84
  v_exp_f32 v85, v85
  v_exp_f32 v86, v86
  v_mfma_f32_16x16x32_bf16 v[36:39], v[126:129], v[224:227], v[36:39]
  buffer_load_dwordx4 a[20:23], v2, s[48:51], s37 offen offset:1024 sc1
  v_exp_f32 v87, v87
  v_add_f32 v84, 1.0, v84
  v_add_f32 v85, 1.0, v85
  v_add_f32 v86, 1.0, v86
  v_add_f32 v87, 1.0, v87
  v_rcp_f32 v84, v84
  v_rcp_f32 v85, v85
  s_waitcnt lgkmcnt(3)
  v_fma_f32 v245, v252, v108, v32
  v_mfma_f32_16x16x32_bf16 v[36:39], v[130:133], v[228:231], v[36:39]
  v_rcp_f32 v86, v86
  v_rcp_f32 v87, v87
  v_mul_f32 v84, v84, v28
  v_mul_f32 v85, v85, v29
  v_mul_f32 v86, v86, v30
  v_mul_f32 v87, v87, v31
  v_cvt_pk_bf16_f32 v102, v84, v85
  v_cvt_pk_bf16_f32 v103, v86, v87
  buffer_store_dwordx4 v[100:103], v13, s[48:51], s76 offen offset:512 sc1
  v_add_f32_dpp v247, v245, v33 wave_shl:1 row_mask:0xf bank_mask:0xf
  v_mfma_f32_16x16x32_bf16 v[36:39], v[134:137], v[232:235], v[36:39]
  v_mfma_f32_16x16x32_bf16 v[36:39], v[138:141], v[236:239], v[36:39]
  buffer_load_dwordx4 a[24:27], v2, s[48:51], s37 offen offset:2048 sc1
  v_add_f32_dpp v249, v247, v34 wave_shl:1 row_mask:0xf bank_mask:0xf
  v_mfma_f32_16x16x32_bf16 v[36:39], v[142:145], v[240:243], v[36:39]
  v_mfma_f32_16x16x32_bf16 v[40:43], v[114:117], v[214:217], 0
  v_add_f32_dpp v250, v249, v35 wave_shl:1 row_mask:0xf bank_mask:0xf
  v_mfma_f32_16x16x32_bf16 v[40:43], v[118:121], v[218:221], v[40:43]
  buffer_load_dwordx4 a[28:31], v2, s[48:51], s37 offen offset:3072 sc1
  v_mfma_f32_16x16x32_bf16 v[40:43], v[122:125], v[222:225], v[40:43]
  v_mfma_f32_16x16x32_bf16 v[40:43], v[126:129], v[226:229], v[40:43]
  v_mfma_f32_16x16x32_bf16 v[40:43], v[130:133], v[230:233], v[40:43]
  s_add_u32 s37, s37, 4096
  buffer_load_dwordx4 a[32:35], v2, s[48:51], s37 offen offset:0 sc1
  v_add_f32_dpp v246, v245, v37 wave_rol:1 row_mask:0xf bank_mask:0xf
  s_waitcnt lgkmcnt(2)
  v_fma_f32 v244, v253, v108, v36
  v_add_f32_dpp v248, v247, v38 wave_rol:1 row_mask:0xf bank_mask:0xf
  v_mfma_f32_16x16x32_bf16 v[40:43], v[134:137], v[234:237], v[40:43]
  v_add_f32_dpp v251, v249, v39 wave_rol:1 row_mask:0xf bank_mask:0xf
  v_add_f32_dpp v246, v244, v37 wave_shl:1 row_mask:0xf bank_mask:0xf
  ds_read_u16_d16_hi v252, v111 offset:1408
  v_mfma_f32_16x16x32_bf16 v[40:43], v[138:141], v[238:241], v[40:43]
  v_add_f32_dpp v248, v246, v38 wave_shl:1 row_mask:0xf bank_mask:0xf
  ds_read_u16_d16_hi v253, v111 offset:1280
  v_mfma_f32_16x16x32_bf16 v[44:47], v[114:117], v[216:219], 0
  buffer_load_dwordx4 a[36:39], v2, s[48:51], s37 offen offset:1024 sc1
  v_add_f32_dpp v251, v248, v39 wave_shl:1 row_mask:0xf bank_mask:0xf
  v_mfma_f32_16x16x32_bf16 v[44:47], v[118:121], v[220:223], v[44:47]
  v_mfma_f32_16x16x32_bf16 v[44:47], v[122:125], v[224:227], v[44:47]
  v_mfma_f32_16x16x32_bf16 v[44:47], v[126:129], v[228:231], v[44:47]
  buffer_load_dwordx4 a[40:43], v2, s[48:51], s37 offen offset:2048 sc1
  v_add_f32_dpp v247, v244, v41 wave_rol:1 row_mask:0xf bank_mask:0xf
  v_cvt_pk_bf16_f32 v255, v250, v251
  s_waitcnt lgkmcnt(3)
  v_fma_f32 v245, v254, v108, v40
  v_add_f32_dpp v249, v246, v42 wave_rol:1 row_mask:0xf bank_mask:0xf
  v_mfma_f32_16x16x32_bf16 v[44:47], v[130:133], v[232:235], v[44:47]
  v_add_f32_dpp v250, v248, v43 wave_rol:1 row_mask:0xf bank_mask:0xf
  v_add_f32_dpp v247, v245, v41 wave_shl:1 row_mask:0xf bank_mask:0xf
  ds_write_b16 v112, v255 offset:2048
  v_mfma_f32_16x16x32_bf16 v[44:47], v[134:137], v[236:239], v[44:47]
  s_waitcnt vmcnt(5)
  buffer_store_dword v15, v7, s[48:51], s12 offen sc1
  v_add_f32_dpp v249, v247, v42 wave_shl:1 row_mask:0xf bank_mask:0xf
  ds_write_b16_d16_hi v112, v255 offset:1920
  v_mfma_f32_16x16x32_bf16 v[44:47], v[138:141], v[240:243], v[44:47]
  buffer_load_dwordx4 a[44:47], v2, s[48:51], s37 offen offset:3072 sc1
  v_add_f32_dpp v250, v249, v43 wave_shl:1 row_mask:0xf bank_mask:0xf
  v_mfma_f32_16x16x32_bf16 v[32:35], v[114:117], v[218:221], 0
  v_mfma_f32_16x16x32_bf16 v[32:35], v[118:121], v[222:225], v[32:35]
  v_mfma_f32_16x16x32_bf16 v[32:35], v[122:125], v[226:229], v[32:35]
  s_add_u32 s37, s37, 4096
  buffer_load_dwordx4 a[48:51], v2, s[48:51], s37 offen offset:0 sc1
  v_mfma_f32_16x16x32_bf16 v[32:35], v[126:129], v[230:233], v[32:35]
  v_add_f32_dpp v246, v245, v45 wave_rol:1 row_mask:0xf bank_mask:0xf
  s_waitcnt lgkmcnt(4)
  v_fma_f32 v244, v109, v108, v44
  v_add_f32_dpp v248, v247, v46 wave_rol:1 row_mask:0xf bank_mask:0xf
  v_add_f32_dpp v251, v249, v47 wave_rol:1 row_mask:0xf bank_mask:0xf
  v_add_f32_dpp v246, v244, v45 wave_shl:1 row_mask:0xf bank_mask:0xf
  v_mfma_f32_16x16x32_bf16 v[32:35], v[130:133], v[234:237], v[32:35]
  ds_read_u16_d16_hi v254, v111 offset:1152
  v_add_f32_dpp v248, v246, v46 wave_shl:1 row_mask:0xf bank_mask:0xf
  ds_read_u16_d16_hi v109, v111 offset:1024
  v_mfma_f32_16x16x32_bf16 v[32:35], v[134:137], v[238:241], v[32:35]
  buffer_load_dwordx4 a[52:55], v2, s[48:51], s37 offen offset:1024 sc1
  v_add_f32_dpp v251, v248, v47 wave_shl:1 row_mask:0xf bank_mask:0xf
  v_mfma_f32_16x16x32_bf16 v[36:39], v[114:117], v[220:223], 0
  v_mfma_f32_16x16x32_bf16 v[36:39], v[118:121], v[224:227], v[36:39]
  v_mfma_f32_16x16x32_bf16 v[36:39], v[122:125], v[228:231], v[36:39]
  buffer_load_dwordx4 a[56:59], v2, s[48:51], s37 offen offset:2048 sc1
  v_mfma_f32_16x16x32_bf16 v[36:39], v[126:129], v[232:235], v[36:39]
  v_mfma_f32_16x16x32_bf16 v[36:39], v[130:133], v[236:239], v[36:39]
  v_add_f32_dpp v247, v244, v33 wave_rol:1 row_mask:0xf bank_mask:0xf
  v_cvt_pk_bf16_f32 v255, v250, v251
  s_waitcnt lgkmcnt(5)
  v_fma_f32 v245, v252, v108, v32
  v_add_f32_dpp v249, v246, v34 wave_rol:1 row_mask:0xf bank_mask:0xf
  v_add_f32_dpp v250, v248, v35 wave_rol:1 row_mask:0xf bank_mask:0xf
  v_mfma_f32_16x16x32_bf16 v[36:39], v[134:137], v[240:243], v[36:39]
  buffer_load_dwordx4 a[60:63], v2, s[48:51], s37 offen offset:3072 sc1
  v_add_f32_dpp v247, v245, v33 wave_shl:1 row_mask:0xf bank_mask:0xf
  ds_write_b16 v112, v255 offset:1792
  v_mfma_f32_16x16x32_bf16 v[134:137], v[114:117], v[222:225], 0
  v_add_f32_dpp v249, v247, v34 wave_shl:1 row_mask:0xf bank_mask:0xf
  ds_write_b16_d16_hi v112, v255 offset:1664
  v_mfma_f32_16x16x32_bf16 v[134:137], v[118:121], v[226:229], v[134:137]
  v_add_f32_dpp v250, v249, v35 wave_shl:1 row_mask:0xf bank_mask:0xf
  v_mfma_f32_16x16x32_bf16 v[134:137], v[122:125], v[230:233], v[134:137]
  s_add_u32 s37, s37, 4096
  buffer_load_dwordx4 a[64:67], v2, s[48:51], s37 offen offset:0 sc1
  v_add_f32_dpp v246, v245, v37 wave_rol:1 row_mask:0xf bank_mask:0xf
  s_waitcnt lgkmcnt(6)
  v_fma_f32 v244, v253, v108, v36
  v_add_f32_dpp v248, v247, v38 wave_rol:1 row_mask:0xf bank_mask:0xf
  v_mfma_f32_16x16x32_bf16 v[134:137], v[126:129], v[234:237], v[134:137]
  v_add_f32_dpp v251, v249, v39 wave_rol:1 row_mask:0xf bank_mask:0xf
  v_add_f32_dpp v246, v244, v37 wave_shl:1 row_mask:0xf bank_mask:0xf
  ds_read_u16_d16_hi v252, v111 offset:4096
  v_mfma_f32_16x16x32_bf16 v[134:137], v[130:133], v[238:241], v[134:137]
  v_add_f32_dpp v248, v246, v38 wave_shl:1 row_mask:0xf bank_mask:0xf
  ds_read_u16_d16_hi v253, v111 offset:896
  v_mfma_f32_16x16x32_bf16 v[40:43], v[114:117], v[224:227], 0
  buffer_load_dwordx4 a[68:71], v2, s[48:51], s37 offen offset:1024 sc1
  v_add_f32_dpp v251, v248, v39 wave_shl:1 row_mask:0xf bank_mask:0xf
  v_mfma_f32_16x16x32_bf16 v[40:43], v[118:121], v[228:231], v[40:43]
  v_mfma_f32_16x16x32_bf16 v[40:43], v[122:125], v[232:235], v[40:43]
  v_mfma_f32_16x16x32_bf16 v[40:43], v[126:129], v[236:239], v[40:43]
  buffer_load_dwordx4 a[72:75], v2, s[48:51], s37 offen offset:2048 sc1
  v_add_f32_dpp v247, v244, v135 wave_rol:1 row_mask:0xf bank_mask:0xf
  v_cvt_pk_bf16_f32 v255, v250, v251
  s_waitcnt lgkmcnt(5)
  v_fma_f32 v245, v254, v108, v134
  v_add_f32_dpp v249, v246, v136 wave_rol:1 row_mask:0xf bank_mask:0xf
  v_mfma_f32_16x16x32_bf16 v[40:43], v[130:133], v[240:243], v[40:43]
  v_add_f32_dpp v250, v248, v137 wave_rol:1 row_mask:0xf bank_mask:0xf
  v_add_f32_dpp v247, v245, v135 wave_shl:1 row_mask:0xf bank_mask:0xf
  ds_write_b16 v112, v255 offset:1536
  v_mfma_f32_16x16x32_bf16 v[130:133], v[146:149], v[178:181], 0
  v_add_f32_dpp v249, v247, v136 wave_shl:1 row_mask:0xf bank_mask:0xf
  ds_write_b16_d16_hi v112, v255 offset:1408
  v_mfma_f32_16x16x32_bf16 v[130:133], v[150:153], v[182:185], v[130:133]
  buffer_load_dwordx4 a[76:79], v2, s[48:51], s37 offen offset:3072 sc1
  v_add_f32_dpp v250, v249, v137 wave_shl:1 row_mask:0xf bank_mask:0xf
  v_mfma_f32_16x16x32_bf16 v[130:133], v[154:157], v[186:189], v[130:133]
  v_add_f32_dpp v246, v245, v41 wave_rol:1 row_mask:0xf bank_mask:0xf
  s_waitcnt lgkmcnt(6)
  v_fma_f32 v244, v109, v108, v40
  v_add_f32_dpp v248, v247, v42 wave_rol:1 row_mask:0xf bank_mask:0xf
  v_add_f32_dpp v251, v249, v43 wave_rol:1 row_mask:0xf bank_mask:0xf
  v_add_f32_dpp v246, v244, v41 wave_shl:1 row_mask:0xf bank_mask:0xf
  v_mfma_f32_16x16x32_bf16 v[130:133], v[158:161], v[190:193], v[130:133]
  ds_read_u16_d16_hi v254, v111 offset:3968
  v_add_f32_dpp v248, v246, v42 wave_shl:1 row_mask:0xf bank_mask:0xf
  ds_read_u16_d16_hi v109, v111 offset:768
  v_mfma_f32_16x16x32_bf16 v[130:133], v[162:165], v[194:197], v[130:133]
  s_add_u32 s37, s37, 4096
  buffer_load_dwordx4 a[80:83], v2, s[48:51], s37 offen offset:0 sc1
  v_add_f32_dpp v251, v248, v43 wave_shl:1 row_mask:0xf bank_mask:0xf
  v_mfma_f32_16x16x32_bf16 v[130:133], v[166:169], v[198:201], v[130:133]
  v_mfma_f32_16x16x32_bf16 v[130:133], v[170:173], v[202:205], v[130:133]
  v_mfma_f32_16x16x32_bf16 v[130:133], v[174:177], v[206:209], v[130:133]
  buffer_load_dwordx4 a[84:87], v2, s[48:51], s37 offen offset:1024 sc1
  v_mfma_f32_16x16x32_bf16 v[44:47], v[114:117], v[226:229], 0
  v_mfma_f32_16x16x32_bf16 v[44:47], v[118:121], v[230:233], v[44:47]
  v_mfma_f32_16x16x32_bf16 v[44:47], v[122:125], v[234:237], v[44:47]
  buffer_load_dwordx4 a[88:91], v2, s[48:51], s37 offen offset:2048 sc1
  v_cvt_pk_bf16_f32 v255, v250, v251
  v_mfma_f32_16x16x32_bf16 v[44:47], v[126:129], v[238:241], v[44:47]
  v_mfma_f32_16x16x32_bf16 v[32:35], v[146:149], v[180:183], 0
  s_waitcnt lgkmcnt(5)
  v_fma_f32 v143, v252, v110, v130
  v_mfma_f32_16x16x32_bf16 v[32:35], v[150:153], v[184:187], v[32:35]
  buffer_load_dwordx4 a[92:95], v2, s[48:51], s37 offen offset:3072 sc1
  v_add_f32_dpp v145, v143, v131 wave_shl:1 row_mask:0xf bank_mask:0xf
  ds_write_b16 v112, v255 offset:1280
  v_mfma_f32_16x16x32_bf16 v[32:35], v[154:157], v[188:191], v[32:35]
  v_add_f32_dpp v141, v145, v132 wave_shl:1 row_mask:0xf bank_mask:0xf
  ds_write_b16_d16_hi v112, v255 offset:1152
  v_mfma_f32_16x16x32_bf16 v[32:35], v[158:161], v[192:195], v[32:35]
  v_add_f32_dpp v250, v141, v133 wave_shl:1 row_mask:0xf bank_mask:0xf
  v_add_f32_dpp v247, v244, v45 wave_rol:1 row_mask:0xf bank_mask:0xf
  s_waitcnt lgkmcnt(6)
  v_fma_f32 v245, v253, v108, v44
  v_add_f32_dpp v249, v246, v46 wave_rol:1 row_mask:0xf bank_mask:0xf
  v_add_f32_dpp v251, v248, v47 wave_rol:1 row_mask:0xf bank_mask:0xf
  v_mfma_f32_16x16x32_bf16 v[32:35], v[162:165], v[196:199], v[32:35]
  s_add_u32 s37, s37, 4096
  buffer_load_dwordx4 a[96:99], v2, s[48:51], s37 offen offset:0 sc1
  v_add_f32_dpp v247, v245, v45 wave_shl:1 row_mask:0xf bank_mask:0xf
  ds_read_u16_d16_hi v252, v111 offset:3840
  v_mfma_f32_16x16x32_bf16 v[32:35], v[166:169], v[200:203], v[32:35]
  v_add_f32_dpp v249, v247, v46 wave_shl:1 row_mask:0xf bank_mask:0xf
  ds_read_u16_d16_hi v253, v111 offset:640
  v_mfma_f32_16x16x32_bf16 v[32:35], v[170:173], v[204:207], v[32:35]
  v_add_f32_dpp v251, v249, v47 wave_shl:1 row_mask:0xf bank_mask:0xf
  v_mfma_f32_16x16x32_bf16 v[32:35], v[174:177], v[208:211], v[32:35]
  buffer_load_dwordx4 a[100:103], v2, s[48:51], s37 offen offset:1024 sc1
  v_mfma_f32_16x16x32_bf16 v[36:39], v[114:117], v[228:231], 0
  v_mfma_f32_16x16x32_bf16 v[36:39], v[118:121], v[232:235], v[36:39]
  v_mfma_f32_16x16x32_bf16 v[36:39], v[122:125], v[236:239], v[36:39]
  buffer_load_dwordx4 a[104:107], v2, s[48:51], s37 offen offset:2048 sc1
  v_mfma_f32_16x16x32_bf16 v[36:39], v[126:129], v[240:243], v[36:39]
  v_mfma_f32_16x16x32_bf16 v[134:137], v[146:149], v[182:185], 0
  v_mfma_f32_16x16x32_bf16 v[134:137], v[150:153], v[186:189], v[134:137]
  buffer_load_dwordx4 a[108:111], v2, s[48:51], s37 offen offset:3072 sc1
  v_add_f32_dpp v144, v143, v33 wave_rol:1 row_mask:0xf bank_mask:0xf
  v_cvt_pk_bf16_f32 v255, v250, v251
  s_waitcnt lgkmcnt(5)
  v_fma_f32 v142, v254, v110, v32
  v_add_f32_dpp v140, v145, v34 wave_rol:1 row_mask:0xf bank_mask:0xf
  v_mfma_f32_16x16x32_bf16 v[134:137], v[154:157], v[190:193], v[134:137]
  buffer_load_dwordx2 v[104:105], v8, s[48:51], s13 offen sc1
  v_add_f32_dpp v250, v141, v35 wave_rol:1 row_mask:0xf bank_mask:0xf
  v_add_f32_dpp v144, v142, v33 wave_shl:1 row_mask:0xf bank_mask:0xf
  ds_write_b16 v112, v255 offset:4224
  v_mfma_f32_16x16x32_bf16 v[134:137], v[158:161], v[194:197], v[134:137]
  v_add_f32_dpp v140, v144, v34 wave_shl:1 row_mask:0xf bank_mask:0xf
  ds_write_b16_d16_hi v112, v255 offset:1024
  v_mfma_f32_16x16x32_bf16 v[134:137], v[162:165], v[198:201], v[134:137]
  s_add_u32 s37, s37, 4096
  buffer_load_dwordx4 a[112:115], v2, s[48:51], s37 offen offset:0 sc1
  v_add_f32_dpp v250, v140, v35 wave_shl:1 row_mask:0xf bank_mask:0xf
  v_add_f32_dpp v246, v245, v37 wave_rol:1 row_mask:0xf bank_mask:0xf
  s_waitcnt lgkmcnt(6)
  v_fma_f32 v244, v109, v108, v36
  v_mfma_f32_16x16x32_bf16 v[134:137], v[166:169], v[202:205], v[134:137]
  v_add_f32_dpp v248, v247, v38 wave_rol:1 row_mask:0xf bank_mask:0xf
  v_add_f32_dpp v251, v249, v39 wave_rol:1 row_mask:0xf bank_mask:0xf
  v_add_f32_dpp v246, v244, v37 wave_shl:1 row_mask:0xf bank_mask:0xf
  ds_read_u16_d16_hi v254, v111 offset:3712
  v_mfma_f32_16x16x32_bf16 v[134:137], v[170:173], v[206:209], v[134:137]
  v_add_f32_dpp v248, v246, v38 wave_shl:1 row_mask:0xf bank_mask:0xf
  ds_read_u16_d16_hi v109, v111 offset:512
  v_mfma_f32_16x16x32_bf16 v[40:43], v[114:117], v[230:233], 0
  buffer_load_dwordx4 a[116:119], v2, s[48:51], s37 offen offset:1024 sc1
  v_add_f32_dpp v251, v248, v39 wave_shl:1 row_mask:0xf bank_mask:0xf
  v_mfma_f32_16x16x32_bf16 v[40:43], v[118:121], v[234:237], v[40:43]
  v_mfma_f32_16x16x32_bf16 v[40:43], v[122:125], v[238:241], v[40:43]
  v_mfma_f32_16x16x32_bf16 v[130:133], v[146:149], v[184:187], 0
  buffer_load_dwordx4 a[120:123], v2, s[48:51], s37 offen offset:2048 sc1
  v_add_f32_dpp v145, v142, v135 wave_rol:1 row_mask:0xf bank_mask:0xf
  v_cvt_pk_bf16_f32 v255, v250, v251
  s_waitcnt lgkmcnt(5)
  v_fma_f32 v143, v252, v110, v134
  v_add_f32_dpp v141, v144, v136 wave_rol:1 row_mask:0xf bank_mask:0xf
  v_mfma_f32_16x16x32_bf16 v[130:133], v[150:153], v[188:191], v[130:133]
  v_add_f32_dpp v250, v140, v137 wave_rol:1 row_mask:0xf bank_mask:0xf
  v_add_f32_dpp v145, v143, v135 wave_shl:1 row_mask:0xf bank_mask:0xf
  ds_write_b16 v112, v255 offset:4096
  v_mfma_f32_16x16x32_bf16 v[130:133], v[154:157], v[192:195], v[130:133]
  v_add_f32_dpp v141, v145, v136 wave_shl:1 row_mask:0xf bank_mask:0xf
  ds_write_b16_d16_hi v112, v255 offset:896
  v_mfma_f32_16x16x32_bf16 v[130:133], v[158:161], v[196:199], v[130:133]
  buffer_load_dwordx4 a[124:127], v2, s[48:51], s37 offen offset:3072 sc1
  v_add_f32_dpp v250, v141, v137 wave_shl:1 row_mask:0xf bank_mask:0xf
  v_add_f32_dpp v247, v244, v41 wave_rol:1 row_mask:0xf bank_mask:0xf
  s_waitcnt lgkmcnt(6)
  v_fma_f32 v245, v253, v108, v40
  v_add_f32_dpp v249, v246, v42 wave_rol:1 row_mask:0xf bank_mask:0xf
  v_mfma_f32_16x16x32_bf16 v[130:133], v[162:165], v[200:203], v[130:133]
  v_add_f32_dpp v251, v248, v43 wave_rol:1 row_mask:0xf bank_mask:0xf
  v_add_f32_dpp v247, v245, v41 wave_shl:1 row_mask:0xf bank_mask:0xf
  ds_read_u16_d16_hi v252, v111 offset:3584
  v_mfma_f32_16x16x32_bf16 v[130:133], v[166:169], v[204:207], v[130:133]
  v_add_f32_dpp v249, v247, v42 wave_shl:1 row_mask:0xf bank_mask:0xf
  ds_read_u16_d16_hi v253, v111 offset:384
  v_mfma_f32_16x16x32_bf16 v[130:133], v[170:173], v[208:211], v[130:133]
  s_add_u32 s37, s37, 4096
  buffer_load_dwordx4 a[128:131], v2, s[48:51], s37 offen offset:0 sc1
  v_add_f32_dpp v251, v249, v43 wave_shl:1 row_mask:0xf bank_mask:0xf
  v_mfma_f32_16x16x32_bf16 v[44:47], v[114:117], v[232:235], 0
  v_mfma_f32_16x16x32_bf16 v[44:47], v[118:121], v[236:239], v[44:47]
  v_mfma_f32_16x16x32_bf16 v[44:47], v[122:125], v[240:243], v[44:47]
  s_waitcnt vmcnt(5)
  v_cmp_ne_u32 vcc, s60, v104
  s_cbranch_vccz Lgot_8
Lpoll_7:
  s_sleep 1
  buffer_load_dwordx2 v[104:105], v8, s[48:51], s13 offen sc1
  s_waitcnt vmcnt(0)
  s_sub_u32 s79, s79, 1
  s_cbranch_scc1 Lend
  v_cmp_ne_u32 vcc, s60, v104
  s_cbranch_vccnz Lpoll_7
Lgot_8:
  v_mov_b32 v6, v105
  buffer_load_dwordx4 v[48:51], v2, s[48:51], s16 offen offset:0 sc1
  v_add_f32_dpp v144, v143, v131 wave_rol:1 row_mask:0xf bank_mask:0xf
  v_mfma_f32_16x16x32_bf16 v[32:35], v[146:149], v[186:189], 0
  v_cvt_pk_bf16_f32 v255, v250, v251
  s_waitcnt lgkmcnt(5)
  v_fma_f32 v142, v254, v110, v130
  v_add_f32_dpp v140, v145, v132 wave_rol:1 row_mask:0xf bank_mask:0xf
  v_add_f32_dpp v250, v141, v133 wave_rol:1 row_mask:0xf bank_mask:0xf
  v_add_f32_dpp v144, v142, v131 wave_shl:1 row_mask:0xf bank_mask:0xf
  v_mfma_f32_16x16x32_bf16 v[32:35], v[150:153], v[190:193], v[32:35]
  ds_write_b16 v112, v255 offset:3968
  v_add_f32_dpp v140, v144, v132 wave_shl:1 row_mask:0xf bank_mask:0xf
  ds_write_b16_d16_hi v112, v255 offset:768
  v_mfma_f32_16x16x32_bf16 v[32:35], v[154:157], v[194:197], v[32:35]
  buffer_load_dwordx4 v[52:55], v2, s[48:51], s16 offen offset:1024 sc1
  v_add_f32_dpp v250, v140, v133 wave_shl:1 row_mask:0xf bank_mask:0xf
  v_add_f32_dpp v246, v245, v45 wave_rol:1 row_mask:0xf bank_mask:0xf
  s_waitcnt lgkmcnt(6)
  v_fma_f32 v244, v109, v108, v44
  v_add_f32_dpp v248, v247, v46 wave_rol:1 row_mask:0xf bank_mask:0xf
  v_mfma_f32_16x16x32_bf16 v[32:35], v[158:161], v[198:201], v[32:35]
  v_add_f32_dpp v251, v249, v47 wave_rol:1 row_mask:0xf bank_mask:0xf
  v_add_f32_dpp v246, v244, v45 wave_shl:1 row_mask:0xf bank_mask:0xf
  ds_read_u16_d16_hi v254, v111 offset:3456
  v_mfma_f32_16x16x32_bf16 v[32:35], v[162:165], v[202:205], v[32:35]
  v_add_f32_dpp v248, v246, v46 wave_shl:1 row_mask:0xf bank_mask:0xf
  ds_read_u16_d16_hi v109, v111 offset:256
  v_mfma_f32_16x16x32_bf16 v[32:35], v[166:169], v[206:209], v[32:35]
  buffer_load_dwordx4 v[56:59], v2, s[48:51], s16 offen offset:2048 sc1
  v_add_f32_dpp v251, v248, v47 wave_shl:1 row_mask:0xf bank_mask:0xf
  v_mfma_f32_16x16x32_bf16 v[36:39], v[114:117], v[234:237], 0
  v_mfma_f32_16x16x32_bf16 v[36:39], v[118:121], v[238:241], v[36:39]
  v_mfma_f32_16x16x32_bf16 v[134:137], v[146:149], v[188:191], 0
  buffer_load_dwordx4 v[60:63], v2, s[48:51], s16 offen offset:3072 sc1
  v_mfma_f32_16x16x32_bf16 v[134:137], v[150:153], v[192:195], v[134:137]
  v_mfma_f32_16x16x32_bf16 v[134:137], v[154:157], v[196:199], v[134:137]
  v_add_f32_dpp v145, v142, v33 wave_rol:1 row_mask:0xf bank_mask:0xf
  v_cvt_pk_bf16_f32 v255, v250, v251
  s_waitcnt lgkmcnt(5)
  v_fma_f32 v143, v252, v110, v32
  v_add_f32_dpp v141, v144, v34 wave_rol:1 row_mask:0xf bank_mask:0xf
  v_add_f32_dpp v250, v140, v35 wave_rol:1 row_mask:0xf bank_mask:0xf
  v_mfma_f32_16x16x32_bf16 v[134:137], v[158:161], v[200:203], v[134:137]
  buffer_load_dwordx4 v[64:67], v4, s[48:51], s16 offen offset:0 sc1
  v_add_f32_dpp v145, v143, v33 wave_shl:1 row_mask:0xf bank_mask:0xf
  ds_write_b16 v112, v255 offset:3840
  v_mfma_f32_16x16x32_bf16 v[134:137], v[162:165], v[204:207], v[134:137]
  v_add_f32_dpp v141, v145, v34 wave_shl:1 row_mask:0xf bank_mask:0xf
  ds_write_b16_d16_hi v112, v255 offset:640
  v_mfma_f32_16x16x32_bf16 v[134:137], v[166:169], v[208:211], v[134:137]
  v_add_f32_dpp v250, v141, v35 wave_shl:1 row_mask:0xf bank_mask:0xf
  v_add_f32_dpp v247, v244, v37 wave_rol:1 row_mask:0xf bank_mask:0xf
  s_waitcnt lgkmcnt(6)
  v_fma_f32 v245, v253, v108, v36
  v_add_f32_dpp v249, v246, v38 wave_rol:1 row_mask:0xf bank_mask:0xf
  v_add_f32_dpp v251, v248, v39 wave_rol:1 row_mask:0xf bank_mask:0xf
  v_mfma_f32_16x16x32_bf16 v[40:43], v[114:117], v[236:239], 0
  buffer_load_dwordx4 v[68:71], v4, s[48:51], s16 offen offset:1024 sc1
  v_add_f32_dpp v247, v245, v37 wave_shl:1 row_mask:0xf bank_mask:0xf
  ds_read_u16_d16_hi v252, v111 offset:3328
  v_mfma_f32_16x16x32_bf16 v[40:43], v[118:121], v[240:243], v[40:43]
  v_add_f32_dpp v249, v247, v38 wave_shl:1 row_mask:0xf bank_mask:0xf
  ds_read_u16_d16_hi v253, v111 offset:128
  v_mfma_f32_16x16x32_bf16 v[130:133], v[146:149], v[190:193], 0
  v_add_f32_dpp v251, v249, v39 wave_shl:1 row_mask:0xf bank_mask:0xf
  v_add_f32_dpp v144, v143, v135 wave_rol:1 row_mask:0xf bank_mask:0xf
  v_cvt_pk_bf16_f32 v255, v250, v251
  s_waitcnt lgkmcnt(5)
  v_fma_f32 v142, v254, v110, v134
  v_add_f32_dpp v140, v145, v136 wave_rol:1 row_mask:0xf bank_mask:0xf
  v_mfma_f32_16x16x32_bf16 v[130:133], v[150:153], v[194:197], v[130:133]
  buffer_load_dwordx4 v[72:75], v4, s[48:51], s16 offen offset:2048 sc1
  v_add_f32_dpp v250, v141, v137 wave_rol:1 row_mask:0xf bank_mask:0xf
  v_add_f32_dpp v144, v142, v135 wave_shl:1 row_mask:0xf bank_mask:0xf
  ds_write_b16 v112, v255 offset:3712
  v_mfma_f32_16x16x32_bf16 v[130:133], v[154:157], v[198:201], v[130:133]
  v_add_f32_dpp v140, v144, v136 wave_shl:1 row_mask:0xf bank_mask:0xf
  ds_write_b16_d16_hi v112, v255 offset:512
  v_mfma_f32_16x16x32_bf16 v[130:133], v[158:161], v[202:205], v[130:133]
  v_add_f32_dpp v250, v140, v137 wave_shl:1 row_mask:0xf bank_mask:0xf
  v_add_f32_dpp v246, v245, v41 wave_rol:1 row_mask:0xf bank_mask:0xf
  s_waitcnt lgkmcnt(6)
  v_fma_f32 v244, v109, v108, v40
  v_add_f32_dpp v248, v247, v42 wave_rol:1 row_mask:0xf bank_mask:0xf
  v_add_f32_dpp v251, v249, v43 wave_rol:1 row_mask:0xf bank_mask:0xf
  v_mfma_f32_16x16x32_bf16 v[130:133], v[162:165], v[206:209], v[130:133]
  buffer_load_dwordx4 v[76:79], v4, s[48:51], s16 offen offset:3072 sc1
  v_add_f32_dpp v246, v244, v41 wave_shl:1 row_mask:0xf bank_mask:0xf
  ds_read_u16_d16_hi v254, v111 offset:3200
  v_mfma_f32_16x16x32_bf16 v[44:47], v[114:117], v[238:241], 0
  v_add_f32_dpp v248, v246, v42 wave_shl:1 row_mask:0xf bank_mask:0xf
  ds_read_u16_d16_hi v109, v111 offset:0
  v_mfma_f32_16x16x32_bf16 v[32:35], v[146:149], v[192:195], 0
  v_add_f32_dpp v251, v248, v43 wave_shl:1 row_mask:0xf bank_mask:0xf
  v_mfma_f32_16x16x32_bf16 v[32:35], v[150:153], v[196:199], v[32:35]
  buffer_load_dwordx4 v[80:83], v5, s[48:51], s16 offen offset:0 sc1
  v_add_f32_dpp v145, v142, v131 wave_rol:1 row_mask:0xf bank_mask:0xf
  v_cvt_pk_bf16_f32 v255, v250, v251
  s_waitcnt lgkmcnt(5)
  v_fma_f32 v143, v252, v110, v130
  v_add_f32_dpp v141, v144, v132 wave_rol:1 row_mask:0xf bank_mask:0xf
  v_mfma_f32_16x16x32_bf16 v[32:35], v[154:157], v[200:203], v[32:35]
  v_add_f32_dpp v250, v140, v133 wave_rol:1 row_mask:0xf bank_mask:0xf
  v_add_f32_dpp v145, v143, v131 wave_shl:1 row_mask:0xf bank_mask:0xf
  ds_write_b16 v112, v255 offset:3584
  v_mfma_f32_16x16x32_bf16 v[32:35], v[158:161], v[204:207], v[32:35]
  v_add_f32_dpp v141, v145, v132 wave_shl:1 row_mask:0xf bank_mask:0xf
  ds_write_b16_d16_hi v112, v255 offset:384
  v_mfma_f32_16x16x32_bf16 v[32:35], v[162:165], v[208:211], v[32:35]
  buffer_load_dwordx4 v[84:87], v5, s[48:51], s16 offen offset:1024 sc1
  v_add_f32_dpp v250, v141, v133 wave_shl:1 row_mask:0xf bank_mask:0xf
  v_add_f32_dpp v247, v244, v45 wave_rol:1 row_mask:0xf bank_mask:0xf
  s_waitcnt lgkmcnt(6)
  v_fma_f32 v245, v253, v108, v44
  v_add_f32_dpp v249, v246, v46 wave_rol:1 row_mask:0xf bank_mask:0xf
  v_mfma_f32_16x16x32_bf16 v[36:39], v[114:117], v[240:243], 0
  v_add_f32_dpp v251, v248, v47 wave_rol:1 row_mask:0xf bank_mask:0xf
  v_add_f32_dpp v247, v245, v45 wave_shl:1 row_mask:0xf bank_mask:0xf
  ds_read_u16_d16_hi v252, v111 offset:3072
  v_mfma_f32_16x16x32_bf16 v[134:137], v[146:149], v[194:197], 0
  v_add_f32_dpp v249, v247, v46 wave_shl:1 row_mask:0xf bank_mask:0xf
  v_mfma_f32_16x16x32_bf16 v[134:137], v[150:153], v[198:201], v[134:137]
  buffer_load_dwordx4 a[132:135], v2, s[48:51], s37 offen offset:1024 sc1
  v_add_f32_dpp v251, v249, v47 wave_shl:1 row_mask:0xf bank_mask:0xf
  v_add_f32_dpp v144, v143, v33 wave_rol:1 row_mask:0xf bank_mask:0xf
  v_cvt_pk_bf16_f32 v255, v250, v251
  s_waitcnt lgkmcnt(4)
  v_fma_f32 v142, v254, v110, v32
  v_mfma_f32_16x16x32_bf16 v[134:137], v[154:157], v[202:205], v[134:137]
  v_add_f32_dpp v140, v145, v34 wave_rol:1 row_mask:0xf bank_mask:0xf
  v_add_f32_dpp v250, v141, v35 wave_rol:1 row_mask:0xf bank_mask:0xf
  v_add_f32_dpp v144, v142, v33 wave_shl:1 row_mask:0xf bank_mask:0xf
  ds_write_b16 v112, v255 offset:3456
  v_mfma_f32_16x16x32_bf16 v[134:137], v[158:161], v[206:209], v[134:137]
  v_add_f32_dpp v140, v144, v34 wave_shl:1 row_mask:0xf bank_mask:0xf
  ds_write_b16_d16_hi v112, v255 offset:256
  v_mfma_f32_16x16x32_bf16 v[40:43], v[146:149], v[196:199], 0
  buffer_load_dwordx4 a[136:139], v2, s[48:51], s37 offen offset:2048 sc1
  v_add_f32_dpp v250, v140, v35 wave_shl:1 row_mask:0xf bank_mask:0xf
  v_add_f32_dpp v246, v245, v37 wave_rol:1 row_mask:0xf bank_mask:0xf
  s_waitcnt lgkmcnt(5)
  v_fma_f32 v244, v109, v108, v36
  v_add_f32_dpp v248, v247, v38 wave_rol:1 row_mask:0xf bank_mask:0xf
  v_mfma_f32_16x16x32_bf16 v[40:43], v[150:153], v[200:203], v[40:43]
  v_add_f32_dpp v251, v249, v39 wave_rol:1 row_mask:0xf bank_mask:0xf
  v_add_f32_dpp v246, v244, v37 wave_shl:1 row_mask:0xf bank_mask:0xf
  ds_read_u16_d16_hi v254, v111 offset:2944
  v_mfma_f32_16x16x32_bf16 v[40:43], v[154:157], v[204:207], v[40:43]
  v_add_f32_dpp v248, v246, v38 wave_shl:1 row_mask:0xf bank_mask:0xf
  ds_read_u16_d16_hi v109, v111 offset:2816
  v_mfma_f32_16x16x32_bf16 v[40:43], v[158:161], v[208:211], v[40:43]
  buffer_load_dwordx4 a[140:143], v2, s[48:51], s37 offen offset:3072 sc1
  v_add_f32_dpp v251, v248, v39 wave_shl:1 row_mask:0xf bank_mask:0xf
  v_add_f32_dpp v145, v142, v135 wave_rol:1 row_mask:0xf bank_mask:0xf
  v_cvt_pk_bf16_f32 v255, v250, v251
  s_waitcnt lgkmcnt(4)
  v_fma_f32 v143, v252, v110, v134
  v_mfma_f32_16x16x32_bf16 v[130:133], v[146:149], v[198:201], 0
  v_add_f32_dpp v141, v144, v136 wave_rol:1 row_mask:0xf bank_mask:0xf
  v_add_f32_dpp v250, v140, v137 wave_rol:1 row_mask:0xf bank_mask:0xf
  v_add_f32_dpp v145, v143, v135 wave_shl:1 row_mask:0xf bank_mask:0xf
  ds_write_b16 v112, v255 offset:3328
  v_mfma_f32_16x16x32_bf16 v[130:133], v[150:153], v[202:205], v[130:133]
  v_add_f32_dpp v141, v145, v136 wave_shl:1 row_mask:0xf bank_mask:0xf
  ds_write_b16_d16_hi v112, v255 offset:128
  v_mfma_f32_16x16x32_bf16 v[130:133], v[154:157], v[206:209], v[130:133]
  s_add_u32 s37, s37, 4096
  buffer_load_dwordx4 a[144:147], v2, s[48:51], s37 offen offset:0 sc1
  v_add_f32_dpp v250, v141, v137 wave_shl:1 row_mask:0xf bank_mask:0xf
  v_mov_b32_dpp v247, v244 wave_rol:1 row_mask:0xf bank_mask:0xf
  v_mov_b32_dpp v249, v246 wave_rol:1 row_mask:0xf bank_mask:0xf
  v_mov_b32_dpp v251, v248 wave_rol:1 row_mask:0xf bank_mask:0xf
  v_mfma_f32_16x16x32_bf16 v[44:47], v[146:149], v[200:203], 0
  ds_read_u16_d16_hi v252, v111 offset:2688
  v_mov_b32_dpp v249, v247 wave_shl:1 row_mask:0xf bank_mask:0xf
  ds_read_u16_d16_hi v253, v111 offset:2560
  v_mfma_f32_16x16x32_bf16 v[44:47], v[150:153], v[204:207], v[44:47]
  v_mov_b32_dpp v251, v249 wave_shl:1 row_mask:0xf bank_mask:0xf
  v_cvt_pk_bf16_f32 v255, v250, v251
  ds_write_b16 v112, v255 offset:3200
  ds_write_b16_d16_hi v112, v255 offset:0
  ds_read_b128 v[96:99], v113 offset:122
  ds_read_b128 v[100:103], v113 offset:1146
  v_mfma_f32_16x16x32_bf16 v[44:47], v[154:157], v[208:211], v[44:47]
  buffer_load_dwordx4 a[148:151], v2, s[48:51], s37 offen offset:1024 sc1
  v_add_f32_dpp v144, v143, v41 wave_rol:1 row_mask:0xf bank_mask:0xf
  s_waitcnt lgkmcnt(9)
  v_fma_f32 v142, v254, v110, v40
  v_add_f32_dpp v140, v145, v42 wave_rol:1 row_mask:0xf bank_mask:0xf
  v_add_f32_dpp v250, v141, v43 wave_rol:1 row_mask:0xf bank_mask:0xf
  v_mfma_f32_16x16x32_bf16 v[32:35], v[146:149], v[202:205], 0
  v_add_f32_dpp v144, v142, v41 wave_shl:1 row_mask:0xf bank_mask:0xf
  v_mfma_f32_16x16x32_bf16 v[32:35], v[150:153], v[206:209], v[32:35]
  v_mfma_f32_16x16x32_bf16 v[36:39], v[146:149], v[204:207], 0
  buffer_load_dwordx4 a[152:155], v2, s[48:51], s37 offen offset:2048 sc1
  v_add_f32_dpp v140, v144, v42 wave_shl:1 row_mask:0xf bank_mask:0xf
  s_branch Lts5
Ltp5:
  s_branch Ltback
Lts5:
  v_mfma_f32_16x16x32_bf16 v[36:39], v[150:153], v[208:211], v[36:39]
  v_mfma_f32_16x16x32_bf16 v[134:137], v[146:149], v[206:209], 0
  v_add_f32_dpp v250, v140, v43 wave_shl:1 row_mask:0xf bank_mask:0xf
  s_waitcnt lgkmcnt(1)
  buffer_store_dwordx4 v[96:99], v2, s[48:51], s23 offen offset:0 sc1
  s_waitcnt lgkmcnt(0)
  buffer_store_dwordx4 v[100:103], v2, s[48:51], s23 offen offset:1024 sc1
  v_add_f32_dpp v145, v142, v131 wave_rol:1 row_mask:0xf bank_mask:0xf
  v_mfma_f32_16x16x32_bf16 v[40:43], v[146:149], v[208:211], 0
  buffer_load_dwordx4 a[156:159], v2, s[48:51], s37 offen offset:3072 sc1
  v_fma_f32 v143, v109, v110, v130
  v_add_f32_dpp v141, v144, v132 wave_rol:1 row_mask:0xf bank_mask:0xf
  v_add_f32_dpp v251, v140, v133 wave_rol:1 row_mask:0xf bank_mask:0xf
  v_add_f32_dpp v145, v143, v131 wave_shl:1 row_mask:0xf bank_mask:0xf
  ds_read_u16_d16_hi v254, v111 offset:2432
  s_waitcnt vmcnt(18)
  v_mfma_f32_16x16x32_bf16 v[8:11], a[160:163], v[48:51], 0
  v_add_f32_dpp v141, v145, v132 wave_shl:1 row_mask:0xf bank_mask:0xf
  ds_read_u16_d16_hi v109, v111 offset:2304
  v_mfma_f32_16x16x32_bf16 v[12:15], a[164:167], v[48:51], 0
  v_add_f32_dpp v251, v141, v133 wave_shl:1 row_mask:0xf bank_mask:0xf
  v_add_f32_dpp v144, v143, v45 wave_rol:1 row_mask:0xf bank_mask:0xf
  v_cvt_pk_bf16_f32 v255, v250, v251
  v_fma_f32 v142, v252, v110, v44
  v_add_f32_dpp v140, v145, v46 wave_rol:1 row_mask:0xf bank_mask:0xf
  v_add_f32_dpp v250, v141, v47 wave_rol:1 row_mask:0xf bank_mask:0xf
  v_mfma_f32_16x16x32_bf16 v[16:19], a[168:171], v[48:51], 0
  buffer_load_dwordx4 v[88:91], v5, s[48:51], s16 offen offset:2048 sc1
  v_add_f32_dpp v144, v142, v45 wave_shl:1 row_mask:0xf bank_mask:0xf
  ds_write_b16 v112, v255 offset:3072
  v_mfma_f32_16x16x32_bf16 v[20:23], a[172:175], v[48:51], 0
  v_add_f32_dpp v140, v144, v46 wave_shl:1 row_mask:0xf bank_mask:0xf
  ds_write_b16_d16_hi v112, v255 offset:2944
  v_mfma_f32_16x16x32_bf16 v[24:27], a[176:179], v[48:51], 0
  v_add_f32_dpp v250, v140, v47 wave_shl:1 row_mask:0xf bank_mask:0xf
  v_add_f32_dpp v145, v142, v33 wave_rol:1 row_mask:0xf bank_mask:0xf
  v_fma_f32 v143, v253, v110, v32
  v_add_f32_dpp v141, v144, v34 wave_rol:1 row_mask:0xf bank_mask:0xf
  v_add_f32_dpp v251, v140, v35 wave_rol:1 row_mask:0xf bank_mask:0xf
  v_add_f32_dpp v145, v143, v33 wave_shl:1 row_mask:0xf bank_mask:0xf
  s_waitcnt vmcnt(18)
  v_mfma_f32_16x16x32_bf16 v[8:11], a[180:183], v[52:55], v[8:11]
  buffer_load_dwordx4 v[92:95], v5, s[48:51], s16 offen offset:3072 sc1
  ds_read_u16_d16_hi v252, v111 offset:2176
  v_add_f32_dpp v141, v145, v34 wave_shl:1 row_mask:0xf bank_mask:0xf
  v_mfma_f32_16x16x32_bf16 v[12:15], a[184:187], v[52:55], v[12:15]
  v_mfma_f32_16x16x32_bf16 v[16:19], a[188:191], v[52:55], v[16:19]
  v_add_f32_dpp v251, v141, v35 wave_shl:1 row_mask:0xf bank_mask:0xf
  v_add_f32_dpp v144, v143, v37 wave_rol:1 row_mask:0xf bank_mask:0xf
  v_cvt_pk_bf16_f32 v255, v250, v251
  s_waitcnt lgkmcnt(4)
  v_fma_f32 v142, v254, v110, v36
  v_add_f32_dpp v140, v145, v38 wave_rol:1 row_mask:0xf bank_mask:0xf
  v_mfma_f32_16x16x32_bf16 v[20:23], a[192:195], v[52:55], v[20:23]
  buffer_load_dwordx4 v[174:177], v2, s[48:51], s17 offen offset:0 sc1
  v_add_f32_dpp v250, v141, v39 wave_rol:1 row_mask:0xf bank_mask:0xf
  v_add_f32_dpp v144, v142, v37 wave_shl:1 row_mask:0xf bank_mask:0xf
  ds_write_b16 v112, v255 offset:2816
  v_mfma_f32_16x16x32_bf16 v[24:27], a[196:199], v[52:55], v[24:27]
  v_add_f32_dpp v140, v144, v38 wave_shl:1 row_mask:0xf bank_mask:0xf
  ds_write_b16_d16_hi v112, v255 offset:2688
  s_waitcnt vmcnt(19)
  v_mfma_f32_16x16x32_bf16 v[8:11], a[200:203], v[56:59], v[8:11]
  v_add_f32_dpp v250, v140, v39 wave_shl:1 row_mask:0xf bank_mask:0xf
  v_add_f32_dpp v145, v142, v135 wave_rol:1 row_mask:0xf bank_mask:0xf
  s_waitcnt lgkmcnt(5)
  v_fma_f32 v143, v109, v110, v134
  v_add_f32_dpp v141, v144, v136 wave_rol:1 row_mask:0xf bank_mask:0xf
  v_mfma_f32_16x16x32_bf16 v[12:15], a[204:207], v[56:59], v[12:15]
  buffer_load_dwordx4 v[178:181], v2, s[48:51], s17 offen offset:1024 sc1
  v_add_f32_dpp v251, v140, v137 wave_rol:1 row_mask:0xf bank_mask:0xf
  v_add_f32_dpp v145, v143, v135 wave_shl:1 row_mask:0xf bank_mask:0xf
  v_mfma_f32_16x16x32_bf16 v[16:19], a[208:211], v[56:59], v[16:19]
  v_mfma_f32_16x16x32_bf16 v[20:23], a[212:215], v[56:59], v[20:23]
  v_add_f32_dpp v141, v145, v136 wave_shl:1 row_mask:0xf bank_mask:0xf
  v_mfma_f32_16x16x32_bf16 v[24:27], a[216:219], v[56:59], v[24:27]
  buffer_load_dwordx4 v[170:173], v2, s[48:51], s17 offen offset:2048 sc1
  v_add_f32_dpp v251, v141, v137 wave_shl:1 row_mask:0xf bank_mask:0xf
  v_add_f32_dpp v144, v143, v41 wave_rol:1 row_mask:0xf bank_mask:0xf
  v_cvt_pk_bf16_f32 v255, v250, v251
  s_waitcnt lgkmcnt(2)
  v_fma_f32 v142, v252, v110, v40
  s_waitcnt vmcnt(20)
  v_mfma_f32_16x16x32_bf16 v[8:11], a[220:223], v[60:63], v[8:11]
  v_add_f32_dpp v140, v145, v42 wave_rol:1 row_mask:0xf bank_mask:0xf
  v_add_f32_dpp v250, v141, v43 wave_rol:1 row_mask:0xf bank_mask:0xf
  v_add_f32_dpp v144, v142, v41 wave_shl:1 row_mask:0xf bank_mask:0xf
  ds_write_b16 v112, v255 offset:2560
  v_mfma_f32_16x16x32_bf16 v[12:15], a[224:227], v[60:63], v[12:15]
  v_add_f32_dpp v140, v144, v42 wave_shl:1 row_mask:0xf bank_mask:0xf
  ds_write_b16_d16_hi v112, v255 offset:2432
  v_mfma_f32_16x16x32_bf16 v[16:19], a[228:231], v[60:63], v[16:19]
  buffer_load_dwordx4 v[182:185], v2, s[48:51], s17 offen offset:3072 sc1
  v_add_f32_dpp v250, v140, v43 wave_shl:1 row_mask:0xf bank_mask:0xf
  v_mov_b32_dpp v145, v142 wave_rol:1 row_mask:0xf bank_mask:0xf
  v_mov_b32_dpp v141, v144 wave_rol:1 row_mask:0xf bank_mask:0xf
  v_mov_b32_dpp v251, v140 wave_rol:1 row_mask:0xf bank_mask:0xf
  v_mfma_f32_16x16x32_bf16 v[20:23], a[232:235], v[60:63], v[20:23]
  v_mov_b32_dpp v141, v145 wave_shl:1 row_mask:0xf bank_mask:0xf
  v_mfma_f32_16x16x32_bf16 v[24:27], a[236:239], v[60:63], v[24:27]
  s_waitcnt vmcnt(20)
  v_mfma_f32_16x16x32_bf16 v[8:11], a[0:3], v[64:67], v[8:11]
  v_mov_b32_dpp v251, v141 wave_shl:1 row_mask:0xf bank_mask:0xf
  v_cvt_pk_bf16_f32 v255, v250, v251
  ds_write_b16 v112, v255 offset:2304
  ds_write_b16_d16_hi v112, v255 offset:2176
  ds_read_b128 v[96:99], v113 offset:2298
  v_mfma_f32_16x16x32_bf16 v[12:15], a[4:7], v[64:67], v[12:15]
  ds_read_b128 v[100:103], v113 offset:3322
  v_mfma_f32_16x16x32_bf16 v[16:19], a[8:11], v[64:67], v[16:19]
  v_mfma_f32_16x16x32_bf16 v[20:23], a[12:15], v[64:67], v[20:23]
  v_mfma_f32_16x16x32_bf16 v[24:27], a[16:19], v[64:67], v[24:27]
  s_waitcnt vmcnt(19)
  v_mfma_f32_16x16x32_bf16 v[8:11], a[20:23], v[68:71], v[8:11]
  s_waitcnt lgkmcnt(1)
  buffer_store_dwordx4 v[96:99], v2, s[48:51], s61 offen offset:2048 sc1
  v_mfma_f32_16x16x32_bf16 v[12:15], a[24:27], v[68:71], v[12:15]
  v_mfma_f32_16x16x32_bf16 v[16:19], a[28:31], v[68:71], v[16:19]
  v_mfma_f32_16x16x32_bf16 v[20:23], a[32:35], v[68:71], v[20:23]
  v_mfma_f32_16x16x32_bf16 v[24:27], a[36:39], v[68:71], v[24:27]
  s_waitcnt lgkmcnt(0)
  buffer_store_dwordx4 v[100:103], v2, s[48:51], s61 offen offset:3072 sc1
  s_waitcnt vmcnt(20)
  v_mfma_f32_16x16x32_bf16 v[8:11], a[40:43], v[72:75], v[8:11]
  v_mfma_f32_16x16x32_bf16 v[12:15], a[44:47], v[72:75], v[12:15]
  v_mfma_f32_16x16x32_bf16 v[16:19], a[48:51], v[72:75], v[16:19]
  v_mfma_f32_16x16x32_bf16 v[20:23], a[52:55], v[72:75], v[20:23]
  v_mfma_f32_16x16x32_bf16 v[24:27], a[56:59], v[72:75], v[24:27]
  s_waitcnt vmcnt(19)
  v_mfma_f32_16x16x32_bf16 v[8:11], a[60:63], v[76:79], v[8:11]
  v_mfma_f32_16x16x32_bf16 v[12:15], a[64:67], v[76:79], v[12:15]
  v_mfma_f32_16x16x32_bf16 v[16:19], a[68:71], v[76:79], v[16:19]
  v_mfma_f32_16x16x32_bf16 v[20:23], a[72:75], v[76:79], v[20:23]
  v_mfma_f32_16x16x32_bf16 v[24:27], a[76:79], v[76:79], v[24:27]
  s_waitcnt lgkmcnt(0)
  s_nop 6
Ljoin:
  s_branch Lts6
Ltp6:
  s_branch Ltback
Lts6:
  s_waitcnt vmcnt(14)
  v_mfma_f32_16x16x32_bf16 v[8:11], a[80:83], v[80:83], v[8:11]
  v_add_u32 v100, s20, v2
  v_mfma_f32_16x16x32_bf16 v[12:15], a[84:87], v[80:83], v[12:15]
  v_add_u32 v101, s21, v2
  v_add_u32 v102, s22, v2
  v_mfma_f32_16x16x32_bf16 v[16:19], a[88:91], v[80:83], v[16:19]
  buffer_load_dwordx4 v[166:169], v4, s[48:51], s17 offen offset:0 sc1
  v_mfma_f32_16x16x32_bf16 v[20:23], a[92:95], v[80:83], v[20:23]
  v_mfma_f32_16x16x32_bf16 v[24:27], a[96:99], v[80:83], v[24:27]
  s_waitcnt vmcnt(14)
  v_mfma_f32_16x16x32_bf16 v[8:11], a[100:103], v[84:87], v[8:11]
  buffer_load_dwordx4 v[186:189], v4, s[48:51], s17 offen offset:1024 sc1
  v_mfma_f32_16x16x32_bf16 v[12:15], a[104:107], v[84:87], v[12:15]
  v_mfma_f32_16x16x32_bf16 v[16:19], a[108:111], v[84:87], v[16:19]
  v_mfma_f32_16x16x32_bf16 v[20:23], a[112:115], v[84:87], v[20:23]
  v_mfma_f32_16x16x32_bf16 v[24:27], a[116:119], v[84:87], v[24:27]
  s_waitcnt vmcnt(7)
  v_mfma_f32_16x16x32_bf16 v[8:11], a[120:123], v[88:91], v[8:11]
  buffer_load_dwordx4 v[162:165], v4, s[48:51], s17 offen offset:2048 sc1
  s_waitcnt vmcnt(7)
  v_mfma_f32_16x16x32_bf16 v[8:11], a[140:143], v[92:95], v[8:11]
  v_mfma_f32_16x16x32_bf16 v[12:15], a[124:127], v[88:91], v[12:15]
  v_mfma_f32_16x16x32_bf16 v[12:15], a[144:147], v[92:95], v[12:15]
  v_mfma_f32_16x16x32_bf16 v[16:19], a[128:131], v[88:91], v[16:19]
  v_mfma_f32_16x16x32_bf16 v[16:19], a[148:151], v[92:95], v[16:19]
  buffer_load_dwordx4 v[190:193], v4, s[48:51], s17 offen offset:3072 sc1
  v_mfma_f32_16x16x32_bf16 v[20:23], a[132:135], v[88:91], v[20:23]
  v_mfma_f32_16x16x32_bf16 v[20:23], a[152:155], v[92:95], v[20:23]
  v_mfma_f32_16x16x32_bf16 v[24:27], a[136:139], v[88:91], v[24:27]
  ds_write_b128 v100, v[8:11] offset:0
  v_mfma_f32_16x16x32_bf16 v[24:27], a[156:159], v[92:95], v[24:27]
  s_waitcnt vmcnt(7)
  v_mfma_f32_16x16x32_bf16 v[28:31], a[160:163], v[174:177], 0
  ds_write_b128 v100, v[12:15] offset:1024
  v_mfma_f32_16x16x32_bf16 v[32:35], a[164:167], v[174:177], 0
  buffer_load_dwordx4 v[158:161], v5, s[48:51], s17 offen offset:0 sc1
  v_mfma_f32_16x16x32_bf16 v[36:39], a[168:171], v[174:177], 0
  ds_write_b128 v100, v[16:19] offset:2048
  v_mfma_f32_16x16x32_bf16 v[40:43], a[172:175], v[174:177], 0
  v_mfma_f32_16x16x32_bf16 v[44:47], a[176:179], v[174:177], 0
  ds_write_b128 v100, v[20:23] offset:3072
  s_waitcnt vmcnt(7)
  v_mfma_f32_16x16x32_bf16 v[28:31], a[180:183], v[178:181], v[28:31]
  buffer_load_dwordx4 v[194:197], v5, s[48:51], s17 offen offset:1024 sc1
  v_mfma_f32_16x16x32_bf16 v[32:35], a[184:187], v[178:181], v[32:35]
  ds_write_b128 v100, v[24:27] offset:4096
  v_mfma_f32_16x16x32_bf16 v[36:39], a[188:191], v[178:181], v[36:39]
  s_waitcnt vmcnt(6)
  buffer_store_dword v107, v0, s[48:51], s15 offen sc1
  v_mfma_f32_16x16x32_bf16 v[40:43], a[192:195], v[178:181], v[40:43]
  v_mfma_f32_16x16x32_bf16 v[44:47], a[196:199], v[178:181], v[44:47]
  v_mfma_f32_16x16x32_bf16 v[28:31], a[200:203], v[170:173], v[28:31]
  buffer_load_dwordx4 v[154:157], v5, s[48:51], s17 offen offset:2048 sc1
  v_mfma_f32_16x16x32_bf16 v[32:35], a[204:207], v[170:173], v[32:35]
  v_mfma_f32_16x16x32_bf16 v[36:39], a[208:211], v[170:173], v[36:39]
  buffer_load_dwordx4 v[198:201], v5, s[48:51], s17 offen offset:3072 sc1
  v_mfma_f32_16x16x32_bf16 v[40:43], a[212:215], v[170:173], v[40:43]
  v_mfma_f32_16x16x32_bf16 v[44:47], a[216:219], v[170:173], v[44:47]
  v_mfma_f32_16x16x32_bf16 v[28:31], a[220:223], v[182:185], v[28:31]
  v_mfma_f32_16x16x32_bf16 v[32:35], a[224:227], v[182:185], v[32:35]
  s_waitcnt lgkmcnt(0)
  s_barrier
  v_mfma_f32_16x16x32_bf16 v[36:39], a[228:231], v[182:185], v[36:39]
  buffer_load_dwordx4 v[150:153], v2, s[48:51], s18 offen offset:0 sc1
  ds_read_b128 v[8:11], v101 offset:0
  v_mfma_f32_16x16x32_bf16 v[40:43], a[232:235], v[182:185], v[40:43]
  ds_read_b128 v[12:15], v101 offset:1024
  ds_read_b128 v[16:19], v101 offset:2048
  v_mfma_f32_16x16x32_bf16 v[44:47], a[236:239], v[182:185], v[44:47]
  ds_read_b128 v[20:23], v101 offset:3072
  ds_read_b128 v[24:27], v101 offset:4096
  s_waitcnt vmcnt(9)
  v_mfma_f32_16x16x32_bf16 v[28:31], a[0:3], v[166:169], v[28:31]
  v_mov_b32 v80, s60
  v_mfma_f32_16x16x32_bf16 v[32:35], a[4:7], v[166:169], v[32:35]
  buffer_store_dword v80, v7, s[48:51], s6 offen sc1
  v_sub_f32 v68, 1.0, v6
  v_mfma_f32_16x16x32_bf16 v[36:39], a[8:11], v[166:169], v[36:39]
  buffer_load_dwordx4 v[202:205], v2, s[48:51], s18 offen offset:1024 sc1
  v_accvgpr_read_b32 v81, a240
  v_mfma_f32_16x16x32_bf16 v[40:43], a[12:15], v[166:169], v[40:43]
  v_lshlrev_b32 v48, 16, v81
  v_and_b32 v49, 0xffff0000, v81
  v_mfma_f32_16x16x32_bf16 v[44:47], a[16:19], v[166:169], v[44:47]
  v_mul_f32 v48, v48, v6
  v_mul_f32 v49, v49, v6
  s_waitcnt vmcnt(10)
  v_mfma_f32_16x16x32_bf16 v[28:31], a[20:23], v[186:189], v[28:31]
  v_accvgpr_read_b32 v82, a241
  v_mfma_f32_16x16x32_bf16 v[32:35], a[24:27], v[186:189], v[32:35]
  v_lshlrev_b32 v50, 16, v82
  v_and_b32 v51, 0xffff0000, v82
  v_mfma_f32_16x16x32_bf16 v[36:39], a[28:31], v[186:189], v[36:39]
  buffer_load_dwordx4 v[146:149], v2, s[48:51], s18 offen offset:2048 sc1
  v_mul_f32 v50, v50, v6
  v_mfma_f32_16x16x32_bf16 v[40:43], a[32:35], v[186:189], v[40:43]
  v_mul_f32 v51, v51, v6
  v_accvgpr_read_b32 v81, a242
  v_mfma_f32_16x16x32_bf16 v[44:47], a[36:39], v[186:189], v[44:47]
  v_lshlrev_b32 v52, 16, v81
  v_and_b32 v53, 0xffff0000, v81
  s_waitcnt vmcnt(10)
  v_mfma_f32_16x16x32_bf16 v[28:31], a[40:43], v[162:165], v[28:31]
  v_mul_f32 v52, v52, v6
  v_mfma_f32_16x16x32_bf16 v[32:35], a[44:47], v[162:165], v[32:35]
  v_mul_f32 v53, v53, v6
  v_accvgpr_read_b32 v82, a243
  v_mfma_f32_16x16x32_bf16 v[36:39], a[48:51], v[162:165], v[36:39]
  buffer_load_dwordx4 v[206:209], v2, s[48:51], s18 offen offset:3072 sc1
  v_lshlrev_b32 v54, 16, v82
  v_mfma_f32_16x16x32_bf16 v[40:43], a[52:55], v[162:165], v[40:43]
  v_and_b32 v55, 0xffff0000, v82
  v_mul_f32 v54, v54, v6
  v_mfma_f32_16x16x32_bf16 v[44:47], a[56:59], v[162:165], v[44:47]
  v_mul_f32 v55, v55, v6
  v_accvgpr_read_b32 v81, a244
  s_waitcnt vmcnt(10)
  v_mfma_f32_16x16x32_bf16 v[28:31], a[60:63], v[190:193], v[28:31]
  v_lshlrev_b32 v56, 16, v81
  v_mfma_f32_16x16x32_bf16 v[32:35], a[64:67], v[190:193], v[32:35]
  v_and_b32 v57, 0xffff0000, v81
  v_mul_f32 v56, v56, v6
  v_mfma_f32_16x16x32_bf16 v[36:39], a[68:71], v[190:193], v[36:39]
  buffer_load_dwordx4 v[142:145], v4, s[48:51], s18 offen offset:0 sc1
  v_mul_f32 v57, v57, v6
  v_mfma_f32_16x16x32_bf16 v[40:43], a[72:75], v[190:193], v[40:43]
  v_accvgpr_read_b32 v82, a245
  v_lshlrev_b32 v58, 16, v82
  v_mfma_f32_16x16x32_bf16 v[44:47], a[76:79], v[190:193], v[44:47]
  v_and_b32 v59, 0xffff0000, v82
  v_mul_f32 v58, v58, v6
  s_waitcnt vmcnt(10)
  v_mfma_f32_16x16x32_bf16 v[28:31], a[80:83], v[158:161], v[28:31]
  v_mul_f32 v59, v59, v6
  v_mfma_f32_16x16x32_bf16 v[32:35], a[84:87], v[158:161], v[32:35]
  v_accvgpr_read_b32 v81, a246
  v_lshlrev_b32 v60, 16, v81
  v_mfma_f32_16x16x32_bf16 v[36:39], a[88:91], v[158:161], v[36:39]
  buffer_load_dwordx4 v[210:213], v4, s[48:51], s18 offen offset:1024 sc1
  v_and_b32 v61, 0xffff0000, v81
  v_mfma_f32_16x16x32_bf16 v[40:43], a[92:95], v[158:161], v[40:43]
  v_mul_f32 v60, v60, v6
  v_mul_f32 v61, v61, v6
  v_mfma_f32_16x16x32_bf16 v[44:47], a[96:99], v[158:161], v[44:47]
  v_accvgpr_read_b32 v82, a247
  v_lshlrev_b32 v62, 16, v82
  s_waitcnt vmcnt(10)
  v_mfma_f32_16x16x32_bf16 v[28:31], a[100:103], v[194:197], v[28:31]
  v_and_b32 v63, 0xffff0000, v82
  v_mfma_f32_16x16x32_bf16 v[32:35], a[104:107], v[194:197], v[32:35]
  v_mul_f32 v62, v62, v6
  v_mul_f32 v63, v63, v6
  v_mfma_f32_16x16x32_bf16 v[36:39], a[108:111], v[194:197], v[36:39]
  buffer_load_dwordx4 v[138:141], v4, s[48:51], s18 offen offset:2048 sc1
  v_accvgpr_read_b32 v81, a248
  v_mfma_f32_16x16x32_bf16 v[40:43], a[112:115], v[194:197], v[40:43]
  v_lshlrev_b32 v64, 16, v81
  v_and_b32 v65, 0xffff0000, v81
  v_mfma_f32_16x16x32_bf16 v[44:47], a[116:119], v[194:197], v[44:47]
  v_mul_f32 v64, v64, v6
  v_mul_f32 v65, v65, v6
  s_waitcnt vmcnt(9)
  v_mfma_f32_16x16x32_bf16 v[28:31], a[120:123], v[154:157], v[28:31]
  v_accvgpr_read_b32 v82, a249
  s_waitcnt vmcnt(8)
  v_mfma_f32_16x16x32_bf16 v[28:31], a[140:143], v[198:201], v[28:31]
  v_lshlrev_b32 v66, 16, v82
  v_mfma_f32_16x16x32_bf16 v[32:35], a[124:127], v[154:157], v[32:35]
  buffer_load_dwordx4 v[214:217], v4, s[48:51], s18 offen offset:3072 sc1
  v_and_b32 v67, 0xffff0000, v82
  v_mfma_f32_16x16x32_bf16 v[32:35], a[144:147], v[198:201], v[32:35]
  v_mul_f32 v66, v66, v6
  v_mul_f32 v67, v67, v6
  v_mfma_f32_16x16x32_bf16 v[36:39], a[128:131], v[154:157], v[36:39]
  ds_write_b128 v100, v[28:31] offset:20480
  v_mfma_f32_16x16x32_bf16 v[36:39], a[148:151], v[198:201], v[36:39]
  v_mfma_f32_16x16x32_bf16 v[40:43], a[132:135], v[154:157], v[40:43]
  v_mfma_f32_16x16x32_bf16 v[40:43], a[152:155], v[198:201], v[40:43]
  buffer_load_dwordx4 v[134:137], v5, s[48:51], s18 offen offset:0 sc1
  ds_write_b128 v100, v[32:35] offset:21504
  v_mfma_f32_16x16x32_bf16 v[44:47], a[136:139], v[154:157], v[44:47]
  v_mfma_f32_16x16x32_bf16 v[44:47], a[156:159], v[198:201], v[44:47]
  s_waitcnt lgkmcnt(6) vmcnt(9)
  v_mfma_f32_16x16x32_bf16 v[8:11], a[160:163], v[150:153], v[8:11]
  ds_write_b128 v100, v[36:39] offset:22528
  s_waitcnt lgkmcnt(6)
  v_mfma_f32_16x16x32_bf16 v[12:15], a[164:167], v[150:153], v[12:15]
  s_waitcnt lgkmcnt(5)
  v_mfma_f32_16x16x32_bf16 v[16:19], a[168:171], v[150:153], v[16:19]
  ds_write_b128 v100, v[40:43] offset:23552
  s_waitcnt lgkmcnt(5)
  v_mfma_f32_16x16x32_bf16 v[20:23], a[172:175], v[150:153], v[20:23]
  buffer_load_dwordx4 v[218:221], v5, s[48:51], s18 offen offset:1024 sc1
  s_waitcnt lgkmcnt(4)
  v_mfma_f32_16x16x32_bf16 v[24:27], a[176:179], v[150:153], v[24:27]
  ds_write_b128 v100, v[44:47] offset:24576
  s_waitcnt vmcnt(8)
  v_mfma_f32_16x16x32_bf16 v[8:11], a[180:183], v[202:205], v[8:11]
  v_mfma_f32_16x16x32_bf16 v[12:15], a[184:187], v[202:205], v[12:15]
  v_mfma_f32_16x16x32_bf16 v[16:19], a[188:191], v[202:205], v[16:19]
  buffer_load_dwordx4 v[130:133], v5, s[48:51], s18 offen offset:2048 sc1
  v_mfma_f32_16x16x32_bf16 v[20:23], a[192:195], v[202:205], v[20:23]
  v_mfma_f32_16x16x32_bf16 v[24:27], a[196:199], v[202:205], v[24:27]
  s_waitcnt vmcnt(8)
  v_mfma_f32_16x16x32_bf16 v[8:11], a[200:203], v[146:149], v[8:11]
  buffer_load_dwordx4 v[222:225], v5, s[48:51], s18 offen offset:3072 sc1
  v_mfma_f32_16x16x32_bf16 v[12:15], a[204:207], v[146:149], v[12:15]
  v_mfma_f32_16x16x32_bf16 v[16:19], a[208:211], v[146:149], v[16:19]
  v_mfma_f32_16x16x32_bf16 v[20:23], a[212:215], v[146:149], v[20:23]
  v_mfma_f32_16x16x32_bf16 v[24:27], a[216:219], v[146:149], v[24:27]
  s_waitcnt vmcnt(8)
  v_mfma_f32_16x16x32_bf16 v[8:11], a[220:223], v[206:209], v[8:11]
  buffer_load_dwordx4 v[126:129], v2, s[48:51], s19 offen offset:0 sc1
  v_mfma_f32_16x16x32_bf16 v[12:15], a[224:227], v[206:209], v[12:15]
  buffer_load_dword v104, v106, s[48:51], s14 offen sc1
  v_mfma_f32_16x16x32_bf16 v[16:19], a[228:231], v[206:209], v[16:19]
  s_waitcnt lgkmcnt(0)
  s_barrier
  v_mfma_f32_16x16x32_bf16 v[20:23], a[232:235], v[206:209], v[20:23]
  ds_read_b128 v[28:31], v101 offset:20480
  ds_read_b128 v[32:35], v101 offset:21504
  v_mfma_f32_16x16x32_bf16 v[24:27], a[236:239], v[206:209], v[24:27]
  ds_read_b128 v[36:39], v101 offset:22528
  ds_read_b128 v[40:43], v101 offset:23552
  s_waitcnt vmcnt(9)
  v_mfma_f32_16x16x32_bf16 v[8:11], a[0:3], v[142:145], v[8:11]
  buffer_load_dwordx4 v[226:229], v2, s[48:51], s19 offen offset:1024 sc1
  v_mfma_f32_16x16x32_bf16 v[12:15], a[4:7], v[142:145], v[12:15]
  ds_read_b128 v[44:47], v101 offset:24576
  v_accvgpr_read_b32 v87, a250
  v_mfma_f32_16x16x32_bf16 v[16:19], a[8:11], v[142:145], v[16:19]
  v_accvgpr_read_b32 v88, a251
  v_accvgpr_read_b32 v89, a252
  v_mfma_f32_16x16x32_bf16 v[20:23], a[12:15], v[142:145], v[20:23]
  v_accvgpr_read_b32 v90, a253
  v_mfma_f32_16x16x32_bf16 v[24:27], a[16:19], v[142:145], v[24:27]
  s_waitcnt vmcnt(9)
  v_mfma_f32_16x16x32_bf16 v[8:11], a[20:23], v[210:213], v[8:11]
  buffer_load_dwordx4 v[122:125], v2, s[48:51], s19 offen offset:2048 sc1
  v_mfma_f32_16x16x32_bf16 v[12:15], a[24:27], v[210:213], v[12:15]
  v_mfma_f32_16x16x32_bf16 v[16:19], a[28:31], v[210:213], v[16:19]
  v_mfma_f32_16x16x32_bf16 v[20:23], a[32:35], v[210:213], v[20:23]
  v_mfma_f32_16x16x32_bf16 v[24:27], a[36:39], v[210:213], v[24:27]
  s_waitcnt vmcnt(9)
  v_mfma_f32_16x16x32_bf16 v[8:11], a[40:43], v[138:141], v[8:11]
  buffer_load_dwordx4 v[230:233], v2, s[48:51], s19 offen offset:3072 sc1
  v_mfma_f32_16x16x32_bf16 v[12:15], a[44:47], v[138:141], v[12:15]
  v_mfma_f32_16x16x32_bf16 v[16:19], a[48:51], v[138:141], v[16:19]
  v_mfma_f32_16x16x32_bf16 v[20:23], a[52:55], v[138:141], v[20:23]
  v_mfma_f32_16x16x32_bf16 v[24:27], a[56:59], v[138:141], v[24:27]
  s_waitcnt vmcnt(9)
  v_mfma_f32_16x16x32_bf16 v[8:11], a[60:63], v[214:217], v[8:11]
  buffer_load_dwordx4 v[118:121], v4, s[48:51], s19 offen offset:0 sc1
  v_mfma_f32_16x16x32_bf16 v[12:15], a[64:67], v[214:217], v[12:15]
  v_mfma_f32_16x16x32_bf16 v[16:19], a[68:71], v[214:217], v[16:19]
  v_mfma_f32_16x16x32_bf16 v[20:23], a[72:75], v[214:217], v[20:23]
  v_mfma_f32_16x16x32_bf16 v[24:27], a[76:79], v[214:217], v[24:27]
  s_waitcnt vmcnt(9)
  v_mfma_f32_16x16x32_bf16 v[8:11], a[80:83], v[134:137], v[8:11]
  buffer_load_dwordx4 v[234:237], v4, s[48:51], s19 offen offset:1024 sc1
  v_mfma_f32_16x16x32_bf16 v[12:15], a[84:87], v[134:137], v[12:15]
  v_mfma_f32_16x16x32_bf16 v[16:19], a[88:91], v[134:137], v[16:19]
  v_mfma_f32_16x16x32_bf16 v[20:23], a[92:95], v[134:137], v[20:23]
  v_mfma_f32_16x16x32_bf16 v[24:27], a[96:99], v[134:137], v[24:27]
  s_waitcnt vmcnt(9)
  v_mfma_f32_16x16x32_bf16 v[8:11], a[100:103], v[218:221], v[8:11]
  buffer_load_dwordx4 v[114:117], v4, s[48:51], s19 offen offset:2048 sc1
  v_mfma_f32_16x16x32_bf16 v[12:15], a[104:107], v[218:221], v[12:15]
  v_mfma_f32_16x16x32_bf16 v[16:19], a[108:111], v[218:221], v[16:19]
  v_mfma_f32_16x16x32_bf16 v[20:23], a[112:115], v[218:221], v[20:23]
  v_mfma_f32_16x16x32_bf16 v[24:27], a[116:119], v[218:221], v[24:27]
  s_waitcnt vmcnt(9)
  v_mfma_f32_16x16x32_bf16 v[8:11], a[120:123], v[130:133], v[8:11]
  buffer_load_dwordx4 v[238:241], v4, s[48:51], s19 offen offset:3072 sc1
  s_waitcnt vmcnt(9)
  v_mfma_f32_16x16x32_bf16 v[8:11], a[140:143], v[222:225], v[8:11]
  v_mfma_f32_16x16x32_bf16 v[12:15], a[124:127], v[130:133], v[12:15]
  v_mfma_f32_16x16x32_bf16 v[12:15], a[144:147], v[222:225], v[12:15]
  v_mfma_f32_16x16x32_bf16 v[16:19], a[128:131], v[130:133], v[16:19]
  v_mfma_f32_16x16x32_bf16 v[16:19], a[148:151], v[222:225], v[16:19]
  buffer_load_dwordx4 v[242:245], v5, s[48:51], s19 offen offset:0 sc1
  s_waitcnt vmcnt(8)
  v_cmp_ne_u32 vcc, s59, v104
  s_cbranch_vccz Lgot_10
Lpoll_9:
  s_sleep 1
  buffer_load_dword v104, v106, s[48:51], s14 offen sc1
  s_waitcnt vmcnt(0)
  s_sub_u32 s79, s79, 1
  s_cbranch_scc1 Lend
  v_cmp_ne_u32 vcc, s59, v104
  s_cbranch_vccnz Lpoll_9
Lgot_10:
  v_mfma_f32_16x16x32_bf16 v[20:23], a[132:135], v[130:133], v[20:23]
  ds_write_b128 v100, v[8:11] offset:40960
  s_add_u32 s53, s77, 4194304
  s_add_u32 m0, s57, 102400
  v_mfma_f32_16x16x32_bf16 v[20:23], a[152:155], v[222:225], v[20:23]
  buffer_load_dwordx4 v3, s[48:51], s53 offen sc1 lds
  s_add_u32 s53, s77, 4329472
  s_add_u32 m0, s57, 106496
  v_mfma_f32_16x16x32_bf16 v[24:27], a[136:139], v[130:133], v[24:27]
  ds_write_b128 v100, v[12:15] offset:41984
  buffer_load_dwordx4 v3, s[48:51], s53 offen sc1 lds
  v_mfma_f32_16x16x32_bf16 v[24:27], a[156:159], v[222:225], v[24:27]
  s_add_u32 s53, s77, 4464640
  s_cmp_lt_u32 s3, 2
  s_cselect_b32 s53, s53, 0x7f000000
  s_add_u32 m0, s57, 110592
  s_waitcnt lgkmcnt(6)
  v_mfma_f32_16x16x32_bf16 v[28:31], a[160:163], v[126:129], v[28:31]
  ds_write_b128 v100, v[16:19] offset:43008
  s_waitcnt lgkmcnt(6)
  v_mfma_f32_16x16x32_bf16 v[32:35], a[164:167], v[126:129], v[32:35]
  buffer_load_dwordx4 v3, s[48:51], s53 offen sc1 lds
  s_waitcnt lgkmcnt(5)
  v_mfma_f32_16x16x32_bf16 v[36:39], a[168:171], v[126:129], v[36:39]
  ds_write_b128 v100, v[20:23] offset:44032
  s_waitcnt lgkmcnt(5)
  v_mfma_f32_16x16x32_bf16 v[40:43], a[172:175], v[126:129], v[40:43]
  buffer_load_dwordx4 v[246:249], v5, s[48:51], s19 offen offset:1024 sc1
  s_waitcnt lgkmcnt(4)
  v_mfma_f32_16x16x32_bf16 v[44:47], a[176:179], v[126:129], v[44:47]
  ds_write_b128 v100, v[24:27] offset:45056
  s_waitcnt vmcnt(11)
  v_mfma_f32_16x16x32_bf16 v[28:31], a[180:183], v[226:229], v[28:31]
  buffer_load_dwordx4 v[250:253], v5, s[48:51], s19 offen offset:2048 sc1
  v_mfma_f32_16x16x32_bf16 v[32:35], a[184:187], v[226:229], v[32:35]
  v_mfma_f32_16x16x32_bf16 v[36:39], a[188:191], v[226:229], v[36:39]
  v_mfma_f32_16x16x32_bf16 v[40:43], a[192:195], v[226:229], v[40:43]
  v_mfma_f32_16x16x32_bf16 v[44:47], a[196:199], v[226:229], v[44:47]
  s_waitcnt vmcnt(11)
  v_mfma_f32_16x16x32_bf16 v[28:31], a[200:203], v[122:125], v[28:31]
  buffer_load_dwordx4 v[108:111], v5, s[48:51], s19 offen offset:3072 sc1
  v_mfma_f32_16x16x32_bf16 v[32:35], a[204:207], v[122:125], v[32:35]
  v_mfma_f32_16x16x32_bf16 v[36:39], a[208:211], v[122:125], v[36:39]
  v_mfma_f32_16x16x32_bf16 v[40:43], a[212:215], v[122:125], v[40:43]
  v_mfma_f32_16x16x32_bf16 v[44:47], a[216:219], v[122:125], v[44:47]
  s_waitcnt lgkmcnt(0)
  s_barrier
  s_waitcnt vmcnt(11)
  v_mfma_f32_16x16x32_bf16 v[28:31], a[220:223], v[230:233], v[28:31]
  ds_read_b128 v[8:11], v102 offset:0
  v_mfma_f32_16x16x32_bf16 v[32:35], a[224:227], v[230:233], v[32:35]
  ds_read_b128 v[12:15], v102 offset:1024
  ds_read_b128 v[16:19], v102 offset:2048
  v_mfma_f32_16x16x32_bf16 v[36:39], a[228:231], v[230:233], v[36:39]
  ds_read_b128 v[20:23], v102 offset:3072
  ds_read_b128 v[24:27], v102 offset:4096
  v_mfma_f32_16x16x32_bf16 v[40:43], a[232:235], v[230:233], v[40:43]
  v_mfma_f32_16x16x32_bf16 v[44:47], a[236:239], v[230:233], v[44:47]
  s_waitcnt vmcnt(10)
  v_mfma_f32_16x16x32_bf16 v[28:31], a[0:3], v[118:121], v[28:31]
  v_mfma_f32_16x16x32_bf16 v[32:35], a[4:7], v[118:121], v[32:35]
  v_mfma_f32_16x16x32_bf16 v[36:39], a[8:11], v[118:121], v[36:39]
  s_waitcnt lgkmcnt(4)
  v_mul_f32 v8, v8, v68
  v_mfma_f32_16x16x32_bf16 v[40:43], a[12:15], v[118:121], v[40:43]
  v_mul_f32 v9, v9, v68
  v_mul_f32 v10, v10, v68
  v_mfma_f32_16x16x32_bf16 v[44:47], a[16:19], v[118:121], v[44:47]
  v_mul_f32 v11, v11, v68
  s_waitcnt lgkmcnt(3)
  v_mul_f32 v12, v12, v68
  s_waitcnt vmcnt(9)
  v_mfma_f32_16x16x32_bf16 v[28:31], a[20:23], v[234:237], v[28:31]
  v_mul_f32 v13, v13, v68
  v_mfma_f32_16x16x32_bf16 v[32:35], a[24:27], v[234:237], v[32:35]
  v_mul_f32 v14, v14, v68
  v_mul_f32 v15, v15, v68
  v_mfma_f32_16x16x32_bf16 v[36:39], a[28:31], v[234:237], v[36:39]
  s_waitcnt lgkmcnt(2)
  v_mul_f32 v16, v16, v68
  v_mfma_f32_16x16x32_bf16 v[40:43], a[32:35], v[234:237], v[40:43]
  v_mul_f32 v17, v17, v68
  v_mul_f32 v18, v18, v68
  v_mfma_f32_16x16x32_bf16 v[44:47], a[36:39], v[234:237], v[44:47]
  v_mul_f32 v19, v19, v68
  s_waitcnt lgkmcnt(1)
  v_mul_f32 v20, v20, v68
  s_waitcnt vmcnt(8)
  v_mfma_f32_16x16x32_bf16 v[28:31], a[40:43], v[114:117], v[28:31]
  v_mul_f32 v21, v21, v68
  v_mfma_f32_16x16x32_bf16 v[32:35], a[44:47], v[114:117], v[32:35]
  v_mul_f32 v22, v22, v68
  v_mul_f32 v23, v23, v68
  v_mfma_f32_16x16x32_bf16 v[36:39], a[48:51], v[114:117], v[36:39]
  s_waitcnt lgkmcnt(0)
  v_mul_f32 v24, v24, v68
  v_mfma_f32_16x16x32_bf16 v[40:43], a[52:55], v[114:117], v[40:43]
  v_mul_f32 v25, v25, v68
  v_mul_f32 v26, v26, v68
  v_mfma_f32_16x16x32_bf16 v[44:47], a[56:59], v[114:117], v[44:47]
  v_mul_f32 v27, v27, v68
  s_waitcnt vmcnt(7)
  v_mfma_f32_16x16x32_bf16 v[28:31], a[60:63], v[238:241], v[28:31]
  v_mfma_f32_16x16x32_bf16 v[32:35], a[64:67], v[238:241], v[32:35]
  v_mfma_f32_16x16x32_bf16 v[36:39], a[68:71], v[238:241], v[36:39]
  v_mfma_f32_16x16x32_bf16 v[40:43], a[72:75], v[238:241], v[40:43]
  v_mfma_f32_16x16x32_bf16 v[44:47], a[76:79], v[238:241], v[44:47]
  s_waitcnt vmcnt(6)
  v_mfma_f32_16x16x32_bf16 v[28:31], a[80:83], v[242:245], v[28:31]
  v_mfma_f32_16x16x32_bf16 v[32:35], a[84:87], v[242:245], v[32:35]
  v_mfma_f32_16x16x32_bf16 v[36:39], a[88:91], v[242:245], v[36:39]
  s_waitcnt vmcnt(3)
  s_barrier
  v_mfma_f32_16x16x32_bf16 v[40:43], a[92:95], v[242:245], v[40:43]
  ds_read_b64_tr_b16 v[70:71], v87 offset:0
  ds_read_b64_tr_b16 v[72:73], v87 offset:512
  v_mfma_f32_16x16x32_bf16 v[44:47], a[96:99], v[242:245], v[44:47]
  ds_read_b64_tr_b16 v[74:75], v87 offset:4096
  ds_read_b64_tr_b16 v[76:77], v87 offset:4608
  s_waitcnt vmcnt(2)
  v_mfma_f32_16x16x32_bf16 v[28:31], a[100:103], v[246:249], v[28:31]
  ds_read_b64_tr_b16 v[78:79], v88 offset:8192
  v_mfma_f32_16x16x32_bf16 v[32:35], a[104:107], v[246:249], v[32:35]
  v_mfma_f32_16x16x32_bf16 v[36:39], a[108:111], v[246:249], v[36:39]
  v_mfma_f32_16x16x32_bf16 v[40:43], a[112:115], v[246:249], v[40:43]
  v_mfma_f32_16x16x32_bf16 v[44:47], a[116:119], v[246:249], v[44:47]
  s_waitcnt lgkmcnt(4)
  v_lshlrev_b32 v80, 16, v70
  s_waitcnt vmcnt(1)
  v_mfma_f32_16x16x32_bf16 v[28:31], a[120:123], v[250:253], v[28:31]
  v_and_b32 v81, 0xffff0000, v70
  s_waitcnt vmcnt(0)
  v_mfma_f32_16x16x32_bf16 v[28:31], a[140:143], v[108:111], v[28:31]
  v_fma_f32 v48, v48, v80, v8
  v_mfma_f32_16x16x32_bf16 v[32:35], a[124:127], v[250:253], v[32:35]
  v_fma_f32 v49, v49, v81, v9
  v_lshlrev_b32 v82, 16, v71
  v_mfma_f32_16x16x32_bf16 v[32:35], a[144:147], v[108:111], v[32:35]
  v_and_b32 v83, 0xffff0000, v71
  v_fma_f32 v50, v50, v82, v10
  v_mfma_f32_16x16x32_bf16 v[36:39], a[128:131], v[250:253], v[36:39]
  v_fma_f32 v51, v51, v83, v11
  s_waitcnt lgkmcnt(3)
  v_lshlrev_b32 v80, 16, v72
  v_mfma_f32_16x16x32_bf16 v[36:39], a[148:151], v[108:111], v[36:39]
  v_and_b32 v81, 0xffff0000, v72
  v_fma_f32 v52, v52, v80, v12
  v_mfma_f32_16x16x32_bf16 v[40:43], a[132:135], v[250:253], v[40:43]
  v_fma_f32 v53, v53, v81, v13
  v_lshlrev_b32 v82, 16, v73
  v_mfma_f32_16x16x32_bf16 v[40:43], a[152:155], v[108:111], v[40:43]
  v_and_b32 v83, 0xffff0000, v73
  v_fma_f32 v54, v54, v82, v14
  v_mfma_f32_16x16x32_bf16 v[44:47], a[136:139], v[250:253], v[44:47]
  v_fma_f32 v55, v55, v83, v15
  s_waitcnt lgkmcnt(2)
  v_lshlrev_b32 v80, 16, v74
  s_branch Lts7
Ltp7:
  s_branch Ltback
Lts7:
  v_mfma_f32_16x16x32_bf16 v[44:47], a[156:159], v[108:111], v[44:47]
  v_and_b32 v81, 0xffff0000, v74
  v_fma_f32 v56, v56, v80, v16
  v_fma_f32 v57, v57, v81, v17
  v_lshlrev_b32 v82, 16, v75
  v_and_b32 v83, 0xffff0000, v75
  v_pk_fma_f32 v[58:59], v[58:59], v[82:83], v[18:19]
  s_waitcnt lgkmcnt(1)
  v_lshlrev_b32 v80, 16, v76
  v_and_b32 v81, 0xffff0000, v76
  v_pk_fma_f32 v[60:61], v[60:61], v[80:81], v[20:21]
  v_lshlrev_b32 v82, 16, v77
  v_and_b32 v83, 0xffff0000, v77
  v_pk_fma_f32 v[62:63], v[62:63], v[82:83], v[22:23]
  s_waitcnt lgkmcnt(0)
  v_lshlrev_b32 v80, 16, v78
  v_and_b32 v81, 0xffff0000, v78
  v_pk_fma_f32 v[64:65], v[64:65], v[80:81], v[24:25]
  v_lshlrev_b32 v82, 16, v79
  v_and_b32 v83, 0xffff0000, v79
  v_pk_fma_f32 v[66:67], v[66:67], v[82:83], v[26:27]
  v_pk_fma_f32 v[48:49], v[28:29], v[68:69], v[48:49] op_sel_hi:[1,0,1]
  v_cvt_pk_bf16_f32 v70, v48, v49
  v_pk_fma_f32 v[50:51], v[30:31], v[68:69], v[50:51] op_sel_hi:[1,0,1]
  v_cvt_pk_bf16_f32 v71, v50, v51
  v_pk_fma_f32 v[52:53], v[32:33], v[68:69], v[52:53] op_sel_hi:[1,0,1]
  v_cvt_pk_bf16_f32 v72, v52, v53
  v_pk_fma_f32 v[54:55], v[34:35], v[68:69], v[54:55] op_sel_hi:[1,0,1]
  v_cvt_pk_bf16_f32 v73, v54, v55
  buffer_store_dwordx4 v[70:73], v89, s[44:47], s56 offen
  v_pk_fma_f32 v[56:57], v[36:37], v[68:69], v[56:57] op_sel_hi:[1,0,1]
  v_cvt_pk_bf16_f32 v74, v56, v57
  v_pk_fma_f32 v[58:59], v[38:39], v[68:69], v[58:59] op_sel_hi:[1,0,1]
  v_cvt_pk_bf16_f32 v75, v58, v59
  v_pk_fma_f32 v[60:61], v[40:41], v[68:69], v[60:61] op_sel_hi:[1,0,1]
  v_cvt_pk_bf16_f32 v76, v60, v61
  v_pk_fma_f32 v[62:63], v[42:43], v[68:69], v[62:63] op_sel_hi:[1,0,1]
  v_cvt_pk_bf16_f32 v77, v62, v63
  buffer_store_dwordx4 v[74:77], v89, s[44:47], s56 offen offset:64
  v_pk_fma_f32 v[64:65], v[44:45], v[68:69], v[64:65] op_sel_hi:[1,0,1]
  v_cvt_pk_bf16_f32 v78, v64, v65
  v_pk_fma_f32 v[66:67], v[46:47], v[68:69], v[66:67] op_sel_hi:[1,0,1]
  v_cvt_pk_bf16_f32 v79, v66, v67
  buffer_store_dwordx2 v[78:79], v90, s[44:47], s56 offen offset:128
Lend:
  s_endpgm

.section .rodata,"a"
.p2align 6
.amdhsa_kernel gated_mix__ssm_conv_h3__dense_activation_silu__prompt_kernel
  .amdhsa_next_free_vgpr 512
  .amdhsa_next_free_sgpr 102
  .amdhsa_accum_offset 256
  .amdhsa_group_segment_fixed_size 0
  .amdhsa_kernarg_size 104
  .amdhsa_user_sgpr_count 2
  .amdhsa_user_sgpr_kernarg_segment_ptr 1
  .amdhsa_system_sgpr_workgroup_id_x 1
.end_amdhsa_kernel
```
